```python
import torch

def _softmax(x, axis=-1):
    return torch.softmax(x, dim=axis)

def _gelu(x):
    return torch.nn.functional.gelu(x, approximate='tanh')

def _silu(x):
    return torch.nn.functional.silu(x)

def _sigmoid(x):
    return torch.sigmoid(x)

def _layernorm(x, axis=-1, eps=1e-05):
    m = x.mean(dim=axis, keepdim=True)
    v = x.var(dim=axis, keepdim=True, unbiased=False)
    return (x - m) / torch.sqrt(v + eps)

def _scatter_add(tgt, idx, src, axis=0):
    return tgt.clone().index_add_(axis, idx, src)

def _segment_sum(src, seg, n):
    out = torch.zeros((n,) + src.shape[1:], dtype=src.dtype)
    return out.index_add_(0, seg, src)

def _pad(x, pw):
    flat = tuple((v for pair in reversed(pw) for v in pair))
    return torch.nn.functional.pad(x, flat)
kernel_name = 'gated_mix__ssm_conv_s4__mixer_gmlp__prompt'

def setup_inputs():

    _w = lambda a: (lambda t: t.to(torch.bfloat16) if t.is_floating_point() else t)(torch.as_tensor(a))

    def _A_setup():
        B, L, D, N = (1, 2048, 640, 192)
        A_re = -(lambda _x: torch.exp(torch.as_tensor(_x)))((lambda *s: torch.randn(*s, dtype=torch.bfloat16) * 3.2)(D, N))
        A_im = torch.pi * (lambda *s: torch.randn(*s, dtype=torch.bfloat16) * 0.1)(D, N)
        B_re = (lambda *s: torch.randn(*s, dtype=torch.bfloat16) * 0.8)(D, N)
        B_im = (lambda *s: torch.randn(*s, dtype=torch.bfloat16) * 0.8)(D, N)
        C_re = (lambda *s: torch.randn(*s, dtype=torch.bfloat16) * 0.8)(D, N)
        C_im = (lambda *s: torch.randn(*s, dtype=torch.bfloat16) * 0.8)(D, N)
        log_dt = (lambda *s: torch.randn(*s, dtype=torch.bfloat16) * 0.1)(D) * 0.5 - 4.0
        Dskip = (lambda *s: torch.randn(*s, dtype=torch.bfloat16) * 0.8)(D)
        return {'u': _w((lambda *s: torch.randn(*s, dtype=torch.bfloat16) * 0.05)(B, L, D)), 'A_re': _w(A_re), 'A_im': _w(A_im), 'B_re': _w(B_re), 'B_im': _w(B_im), 'C_re': _w(C_re), 'C_im': _w(C_im), 'log_dt': _w(log_dt), 'Dskip': _w(Dskip)}
    _A_in = _A_setup()

    def _B_setup():
        B, S, D, F = (1, 2048, 640, 1536)
        Fh = F // 2
        return {'x': _w((lambda *s: torch.randn(*s, dtype=torch.bfloat16) * 0.05)(B, S, D)), 'w_in': _w((lambda *s: torch.randn(*s, dtype=torch.bfloat16) * 0.4)(D, 2 * Fh)), 'w_sp': _w(0.01 * (lambda *s: torch.randn(*s, dtype=torch.bfloat16) * 0.4)(S, S)), 'b_sp': _w(1.0 + 0.01 * (lambda *s: torch.randn(*s, dtype=torch.bfloat16) * 0.05)(S)), 'w_out': _w((lambda *s: torch.randn(*s, dtype=torch.bfloat16) * 0.05)(Fh, D))}
    _B_in = _B_setup()
    return {'A_u': _A_in['u'], 'A_A_re': _A_in['A_re'], 'A_A_im': _A_in['A_im'], 'A_B_re': _A_in['B_re'], 'A_B_im': _A_in['B_im'], 'A_C_re': _A_in['C_re'], 'A_C_im': _A_in['C_im'], 'A_log_dt': _A_in['log_dt'], 'A_Dskip': _A_in['Dskip'], 'B_x': _B_in['x'], 'B_w_in': _B_in['w_in'], 'B_w_sp': _B_in['w_sp'], 'B_b_sp': _B_in['b_sp'], 'B_w_out': _B_in['w_out'], 'gate_w': _w((lambda *s: torch.randn(*s, dtype=torch.bfloat16) * 0.05)(640) * 16.0)}

def reference(A_u, A_A_re, A_A_im, A_B_re, A_B_im, A_C_re, A_C_im, A_log_dt, A_Dskip, B_x, B_w_in, B_w_sp, B_b_sp, B_w_out, gate_w):

    def _A_ref(u, A_re, A_im, B_re, B_im, C_re, C_im, log_dt, Dskip):
        Bsz, L, D = u.shape
        dt = torch.exp(log_dt)[:, None]
        A = A_re + 1j * A_im
        Bc = B_re + 1j * B_im
        Cc = C_re + 1j * C_im
        logdA = dt * A
        dB = dt * Bc
        l = (lambda x, dt: x.to(dt))(torch.arange(L), A_re.dtype)
        P = torch.exp(logdA[:, :, None] * l[None, None, :])
        K = torch.einsum('dn,dnl,dn->dl', Cc, P, dB).real
        L2 = 2 * L
        Kp = _pad(K, ((0, 0), (0, L)))
        up = (lambda x, *d: x.permute(*d))(u, 0, 2, 1)
        up = _pad(up, ((0, 0), (0, 0), (0, L)))
        Kf = (lambda x, axes=(-2, -1): torch.fft.rfft2(x.float(), dim=axes))(Kp[:, None, :], axes=(-2, -1))
        Uf = (lambda x, axes=(-2, -1): torch.fft.rfft2(x.float(), dim=axes))(up[:, :, None, :], axes=(-2, -1))
        Yf = Uf * Kf[None, :, :, :]
        y = (lambda x, s, axes=(-2, -1): torch.fft.irfft2(x, s=s, dim=axes).to(torch.bfloat16))(Yf, (1, L2), axes=(-2, -1))[:, :, 0, :L]
        y = (lambda x, *d: x.permute(*d))(y, 0, 2, 1) + u * Dskip[None, None, :]
        return y

    def _B_ref(x, w_in, w_sp, b_sp, w_out):
        B, S, D = x.shape
        F = w_in.shape[-1]
        Fh = F // 2
        z = _gelu(torch.einsum('bsd,df->bsf', x, w_in))
        z1 = z[..., :Fh].clone()
        z2 = _layernorm(z[..., Fh:], axis=-1)
        g = torch.einsum('ts,bsf->btf', w_sp, z2) + b_sp[None, :, None]
        return torch.einsum('bsf,fd->bsd', z1 * g, w_out)
    x = A_u
    g = _sigmoid((x * gate_w).sum(-1, keepdims=True))
    a = _A_ref(x, A_A_re, A_A_im, A_B_re, A_B_im, A_C_re, A_C_im, A_log_dt, A_Dskip)
    b = _B_ref(x, B_w_in, B_w_sp, B_b_sp, B_w_out)
    return g * a + (1 - g) * b
```

```asm
; @launch grid=(512,1,1) block=(256,1,1) lds=81920
.amdgcn_target "amdgcn-amd-amdhsa--gfx950"
.text
.globl gated_mix__ssm_conv_s4__mixer_gmlp__prompt_kernel
.p2align 8
.type gated_mix__ssm_conv_s4__mixer_gmlp__prompt_kernel,@function
gated_mix__ssm_conv_s4__mixer_gmlp__prompt_kernel:
    s_cmp_ge_u32 s2, 512
    s_cbranch_scc1 L_end
    s_load_dwordx16 s[16:31], s[0:1], 0
    s_load_dwordx16 s[32:47], s[0:1], 64
    s_load_dwordx4 s[48:51], s[0:1], 128
    v_and_b32 v1, 63, v0
    v_lshrrev_b32 v2, 6, v0
    s_nop 0
    v_readfirstlane_b32 s81, v2
    s_cmp_ge_u32 s2, 256
    s_cbranch_scc1 L_side
L_gemm:
    s_setprio 2
    s_and_b32 s91, s2, 7
    s_lshr_b32 s92, s2, 3
    s_lshr_b32 s82, s91, 1
    s_lshl_b32 s82, s82, 3
    s_lshr_b32 s93, s92, 2
    s_add_u32 s82, s82, s93
    s_and_b32 s83, s91, 1
    s_lshl_b32 s83, s83, 2
    s_and_b32 s93, s92, 3
    s_add_u32 s83, s83, s93
    s_lshr_b32 s86, s81, 1
    s_and_b32 s87, s81, 1
    s_mul_i32 s88, s83, 3
    s_add_u32 s88, s88, s82
    s_mul_i32 s91, s88, 205
    s_lshr_b32 s91, s91, 11
    s_mul_i32 s91, s91, 10
    s_sub_u32 s88, s88, s91
    s_mov_b32 s10, s88
    s_lshl_b32 s3, s81, 11
    s_mul_i32 s4, s81, 3072
    s_add_u32 s4, s4, 8192
    s_mul_i32 s94, s82, 81920
    s_mul_i32 s95, s83, 192
    s_add_u32 s95, s95, 1536
    v_lshrrev_b32 v16, 3, v1
    v_and_b32 v17, 7, v1
    v_bfe_u32 v18, v1, 4, 1
    v_xor_b32 v17, v17, v18
    s_lshl_b32 s91, s81, 4
    v_add_u32 v16, s91, v16
    v_mul_u32_u24 v16, 1280, v16
    s_lshl_b32 s91, s87, 2
    v_xor_b32 v17, s91, v17
    v_lshl_add_u32 v2, v17, 4, v16
    v_xor_b32 v17, 2, v17
    v_lshl_add_u32 v3, v17, 4, v16
    v_add_u32 v3, 9216, v3
    s_mul_i32 s91, s81, 192
    v_add_u32 v16, s91, v1
    v_mul_u32_u24 v17, 43691, v16
    v_lshrrev_b32 v17, 19, v17
    v_mul_u32_u24 v18, 12, v17
    v_sub_u32 v16, v16, v18
    v_bfe_u32 v18, v17, 3, 1
    v_mad_u32_u24 v16, v18, 6, v16
    v_subrev_u32 v18, 12, v16
    v_min_u32 v16, v16, v18
    v_mul_u32_u24 v17, 3072, v17
    v_lshl_add_u32 v4, v16, 4, v17
    v_add_u32 v16, s91, v1
    v_add_u32 v16, 64, v16
    v_mul_u32_u24 v17, 43691, v16
    v_lshrrev_b32 v17, 19, v17
    v_mul_u32_u24 v18, 12, v17
    v_sub_u32 v16, v16, v18
    v_bfe_u32 v18, v17, 3, 1
    v_mad_u32_u24 v16, v18, 6, v16
    v_subrev_u32 v18, 12, v16
    v_min_u32 v16, v16, v18
    v_mul_u32_u24 v17, 3072, v17
    v_lshl_add_u32 v5, v16, 4, v17
    v_subrev_u32 v5, 1024, v5
    v_add_u32 v16, s91, v1
    v_add_u32 v16, 128, v16
    v_mul_u32_u24 v17, 43691, v16
    v_lshrrev_b32 v17, 19, v17
    v_mul_u32_u24 v18, 12, v17
    v_sub_u32 v16, v16, v18
    v_bfe_u32 v18, v17, 3, 1
    v_mad_u32_u24 v16, v18, 6, v16
    v_subrev_u32 v18, 12, v16
    v_min_u32 v16, v16, v18
    v_mul_u32_u24 v17, 3072, v17
    v_lshl_add_u32 v6, v16, 4, v17
    v_subrev_u32 v6, 2048, v6
    s_waitcnt lgkmcnt(0)
    s_mov_b32 s52, s16
    s_and_b32 s53, s17, 0xffff
    s_mov_b32 s54, 2621440
    s_mov_b32 s55, 0x00020000
    s_mov_b32 s56, s36
    s_and_b32 s57, s37, 0xffff
    s_mov_b32 s58, 1966080
    s_mov_b32 s59, 0x00020000
    s_lshl_b32 s89, s88, 7
    s_add_u32 s89, s89, s94
    s_add_u32 m0, s3, 0
    s_nop 0
    buffer_load_dwordx4 v2, s[52:55], s89 offen lds
    buffer_load_dwordx4 v3, s[52:55], s89 offen offset:1024 lds
    s_mul_i32 s90, s88, 196608
    s_add_u32 s90, s90, s95
    s_add_u32 m0, s4, 0
    s_add_u32 s88, s88, 1
    buffer_load_dwordx4 v4, s[56:59], s90 offen offset:0 lds
    buffer_load_dwordx4 v5, s[56:59], s90 offen offset:1024 lds
    buffer_load_dwordx4 v6, s[56:59], s90 offen offset:2048 lds
    s_cmp_eq_u32 s88, 10
    s_cselect_b32 s88, 0, s88
    s_lshl_b32 s89, s88, 7
    s_add_u32 s89, s89, s94
    s_add_u32 m0, s3, 20480
    s_nop 0
    buffer_load_dwordx4 v2, s[52:55], s89 offen lds
    buffer_load_dwordx4 v3, s[52:55], s89 offen offset:1024 lds
    s_mul_i32 s90, s88, 196608
    s_add_u32 s90, s90, s95
    s_add_u32 m0, s4, 20480
    s_add_u32 s88, s88, 1
    buffer_load_dwordx4 v4, s[56:59], s90 offen offset:0 lds
    buffer_load_dwordx4 v5, s[56:59], s90 offen offset:1024 lds
    buffer_load_dwordx4 v6, s[56:59], s90 offen offset:2048 lds
    s_cmp_eq_u32 s88, 10
    s_cselect_b32 s88, 0, s88
    s_lshl_b32 s89, s88, 7
    s_add_u32 s89, s89, s94
    s_add_u32 m0, s3, 40960
    s_nop 0
    buffer_load_dwordx4 v2, s[52:55], s89 offen lds
    buffer_load_dwordx4 v3, s[52:55], s89 offen offset:1024 lds
    s_mul_i32 s90, s88, 196608
    s_add_u32 s90, s90, s95
    s_add_u32 m0, s4, 40960
    s_add_u32 s88, s88, 1
    buffer_load_dwordx4 v4, s[56:59], s90 offen offset:0 lds
    buffer_load_dwordx4 v5, s[56:59], s90 offen offset:1024 lds
    buffer_load_dwordx4 v6, s[56:59], s90 offen offset:2048 lds
    s_cmp_eq_u32 s88, 10
    s_cselect_b32 s88, 0, s88
    s_lshl_b32 s89, s88, 7
    s_add_u32 s89, s89, s94
    s_add_u32 m0, s3, 61440
    s_nop 0
    buffer_load_dwordx4 v2, s[52:55], s89 offen lds
    buffer_load_dwordx4 v3, s[52:55], s89 offen offset:1024 lds
    s_mul_i32 s90, s88, 196608
    s_add_u32 s90, s90, s95
    s_add_u32 m0, s4, 61440
    s_add_u32 s88, s88, 1
    buffer_load_dwordx4 v4, s[56:59], s90 offen offset:0 lds
    buffer_load_dwordx4 v5, s[56:59], s90 offen offset:1024 lds
    buffer_load_dwordx4 v6, s[56:59], s90 offen offset:2048 lds
    s_cmp_eq_u32 s88, 10
    s_cselect_b32 s88, 0, s88
    s_mov_b32 s60, s38
    s_and_b32 s61, s39, 0xffff
    s_mov_b32 s62, 8388608
    s_mov_b32 s63, 0x00020000
    s_mov_b32 s72, s46
    s_and_b32 s73, s47, 0xffff
    s_mov_b32 s74, 2621440
    s_mov_b32 s75, 0x00020000
    v_and_b32 v16, 15, v1
    v_lshrrev_b32 v17, 4, v1
    v_lshrrev_b32 v18, 2, v16
    v_lshlrev_b32 v19, 3, v18
    v_and_b32 v7, 3, v16
    v_add_u32 v19, v19, v7
    s_lshl_b32 s91, s86, 5
    v_add_u32 v19, s91, v19
    v_lshlrev_b32 v19, 7, v19
    v_lshlrev_b32 v18, 1, v18
    v_bfe_u32 v7, v16, 1, 1
    v_or_b32 v18, v18, v7
    v_xor_b32 v18, v18, v17
    v_lshl_add_u32 v7, v18, 4, v19
    v_xor_b32 v8, 64, v7
    v_add_u32 v9, 40960, v7
    v_add_u32 v10, 40960, v8
    v_lshrrev_b32 v18, 2, v16
    v_lshl_add_u32 v18, v17, 3, v18
    v_mul_u32_u24 v18, 192, v18
    v_and_b32 v19, 1, v17
    v_xor_b32 v19, s87, v19
    v_mul_u32_u24 v19, 96, v19
    v_add_u32 v18, v18, v19
    v_and_b32 v19, 3, v1
    v_lshl_add_u32 v11, v19, 3, v18
    v_add_u32 v11, 8192, v11
    v_add_u32 v12, 40960, v11
    v_lshrrev_b32 v18, 2, v16
    v_lshl_add_u32 v19, v17, 3, v18
    v_lshlrev_b32 v13, 7, v19
    v_lshrrev_b32 v18, 1, v18
    v_lshl_or_b32 v18, v17, 1, v18
    v_bfe_u32 v19, v1, 1, 1
    s_lshl_b32 s91, s81, 1
    v_add_u32 v19, s91, v19
    v_xor_b32 v19, v19, v18
    v_lshl_add_u32 v13, v19, 4, v13
    v_and_b32 v19, 1, v1
    v_lshl_add_u32 v13, v19, 3, v13
    s_lshl_b32 s91, s81, 4
    v_add_u32 v14, s91, v16
    v_lshlrev_b32 v14, 12, v14
    v_lshl_add_u32 v14, v17, 4, v14
    s_mov_b32 s6, 0xbdd2d3e8
    s_mov_b32 s7, 0xbdd2d3e8
    s_mov_b32 s8, 1.0
    s_mov_b32 s9, 1.0
    s_mov_b32 s68, s50
    s_and_b32 s69, s51, 0xffff
    s_mov_b32 s70, 67108864
    s_mov_b32 s71, 0x00020000
    buffer_load_dword v15, off, s[68:71], 0 sc1
    s_waitcnt vmcnt(16)
    s_barrier
    ds_read_b128 v[96:99], v7 offset:0
    ds_read_b128 v[100:103], v7 offset:512
    ds_read_b64_tr_b16 v[72:73], v11 offset:0
    ds_read_b64_tr_b16 v[74:75], v11 offset:768
    ds_read_b64_tr_b16 v[76:77], v11 offset:32
    ds_read_b64_tr_b16 v[78:79], v11 offset:800
    ds_read_b64_tr_b16 v[80:81], v11 offset:64
    ds_read_b64_tr_b16 v[82:83], v11 offset:832
    ds_read_b128 v[104:107], v8 offset:0
    ds_read_b128 v[108:111], v8 offset:512
    ds_read_b64_tr_b16 v[84:85], v11 offset:6144
    ds_read_b64_tr_b16 v[86:87], v11 offset:6912
    ds_read_b64_tr_b16 v[88:89], v11 offset:6176
    ds_read_b64_tr_b16 v[90:91], v11 offset:6944
    ds_read_b64_tr_b16 v[92:93], v11 offset:6208
    ds_read_b64_tr_b16 v[94:95], v11 offset:6976
    ds_read_b64_tr_b16 v[16:17], v13 offset:0
    ds_read_b64_tr_b16 v[18:19], v13 offset:512
    ds_read_b64_tr_b16 v[20:21], v13 offset:4096
    ds_read_b64_tr_b16 v[22:23], v13 offset:4608
    s_waitcnt lgkmcnt(12)
    v_mfma_f32_16x16x32_bf16 v[24:27], v[96:99], v[72:75], 0
    v_mfma_f32_16x16x32_bf16 v[28:31], v[96:99], v[76:79], 0
    v_mfma_f32_16x16x32_bf16 v[32:35], v[96:99], v[80:83], 0
    v_mfma_f32_16x16x32_bf16 v[36:39], v[100:103], v[72:75], 0
    v_mfma_f32_16x16x32_bf16 v[40:43], v[100:103], v[76:79], 0
    v_mfma_f32_16x16x32_bf16 v[44:47], v[100:103], v[80:83], 0
    s_waitcnt vmcnt(11) lgkmcnt(0)
    s_barrier
    s_mov_b32 s91, s10
    s_lshl_b32 s91, s91, 18
    s_lshl_b32 s92, s82, 7
    s_add_u32 s91, s91, s92
    s_add_u32 s91, s91, 7340032
    buffer_store_dwordx4 v[16:19], v14, s[68:71], s91 offen offset:0 sc1
    buffer_store_dwordx4 v[20:23], v14, s[68:71], s91 offen offset:64 sc1
    ds_read_b128 v[112:115], v7 offset:20480
    ds_read_b128 v[116:119], v7 offset:20992
    ds_read_b64_tr_b16 v[72:73], v11 offset:20480
    ds_read_b64_tr_b16 v[74:75], v11 offset:21248
    ds_read_b64_tr_b16 v[76:77], v11 offset:20512
    ds_read_b64_tr_b16 v[78:79], v11 offset:21280
    ds_read_b64_tr_b16 v[80:81], v11 offset:20544
    ds_read_b64_tr_b16 v[82:83], v11 offset:21312
    s_lshl_b32 s89, s88, 7
    s_add_u32 s89, s89, s94
    s_add_u32 m0, s3, 0
    s_nop 0
    buffer_load_dwordx4 v2, s[52:55], s89 offen lds
    buffer_load_dwordx4 v3, s[52:55], s89 offen offset:1024 lds
    v_mfma_f32_16x16x32_bf16 v[24:27], v[104:107], v[84:87], v[24:27]
    v_mfma_f32_16x16x32_bf16 v[28:31], v[104:107], v[88:91], v[28:31]
    v_mfma_f32_16x16x32_bf16 v[32:35], v[104:107], v[92:95], v[32:35]
    v_mfma_f32_16x16x32_bf16 v[36:39], v[108:111], v[84:87], v[36:39]
    v_mfma_f32_16x16x32_bf16 v[40:43], v[108:111], v[88:91], v[40:43]
    v_mfma_f32_16x16x32_bf16 v[44:47], v[108:111], v[92:95], v[44:47]
    s_mul_i32 s90, s88, 196608
    s_add_u32 s90, s90, s95
    s_add_u32 m0, s4, 0
    s_add_u32 s88, s88, 1
    buffer_load_dwordx4 v4, s[56:59], s90 offen offset:0 lds
    ds_read_b128 v[120:123], v8 offset:20480
    ds_read_b128 v[124:127], v8 offset:20992
    ds_read_b64_tr_b16 v[84:85], v11 offset:26624
    ds_read_b64_tr_b16 v[86:87], v11 offset:27392
    ds_read_b64_tr_b16 v[88:89], v11 offset:26656
    ds_read_b64_tr_b16 v[90:91], v11 offset:27424
    ds_read_b64_tr_b16 v[92:93], v11 offset:26688
    ds_read_b64_tr_b16 v[94:95], v11 offset:27456
    s_waitcnt lgkmcnt(8)
    buffer_load_dwordx4 v5, s[56:59], s90 offen offset:1024 lds
    v_mfma_f32_16x16x32_bf16 v[24:27], v[112:115], v[72:75], v[24:27]
    v_mfma_f32_16x16x32_bf16 v[28:31], v[112:115], v[76:79], v[28:31]
    v_mfma_f32_16x16x32_bf16 v[32:35], v[112:115], v[80:83], v[32:35]
    v_mfma_f32_16x16x32_bf16 v[36:39], v[116:119], v[72:75], v[36:39]
    v_mfma_f32_16x16x32_bf16 v[40:43], v[116:119], v[76:79], v[40:43]
    v_mfma_f32_16x16x32_bf16 v[44:47], v[116:119], v[80:83], v[44:47]
    buffer_load_dwordx4 v6, s[56:59], s90 offen offset:2048 lds
    s_cmp_eq_u32 s88, 10
    s_cselect_b32 s88, 0, s88
    s_waitcnt vmcnt(13) lgkmcnt(0)
    s_barrier
    ds_read_b128 v[128:131], v9 offset:0
    ds_read_b128 v[132:135], v9 offset:512
    ds_read_b64_tr_b16 v[72:73], v12 offset:0
    ds_read_b64_tr_b16 v[74:75], v12 offset:768
    ds_read_b64_tr_b16 v[76:77], v12 offset:32
    ds_read_b64_tr_b16 v[78:79], v12 offset:800
    ds_read_b64_tr_b16 v[80:81], v12 offset:64
    ds_read_b64_tr_b16 v[82:83], v12 offset:832
    s_lshl_b32 s89, s88, 7
    s_add_u32 s89, s89, s94
    s_add_u32 m0, s3, 20480
    s_nop 0
    buffer_load_dwordx4 v2, s[52:55], s89 offen lds
    buffer_load_dwordx4 v3, s[52:55], s89 offen offset:1024 lds
    v_mfma_f32_16x16x32_bf16 v[24:27], v[120:123], v[84:87], v[24:27]
    v_mfma_f32_16x16x32_bf16 v[28:31], v[120:123], v[88:91], v[28:31]
    v_mfma_f32_16x16x32_bf16 v[32:35], v[120:123], v[92:95], v[32:35]
    v_mfma_f32_16x16x32_bf16 v[36:39], v[124:127], v[84:87], v[36:39]
    v_mfma_f32_16x16x32_bf16 v[40:43], v[124:127], v[88:91], v[40:43]
    v_mfma_f32_16x16x32_bf16 v[44:47], v[124:127], v[92:95], v[44:47]
    s_mul_i32 s90, s88, 196608
    s_add_u32 s90, s90, s95
    s_add_u32 m0, s4, 20480
    s_add_u32 s88, s88, 1
    buffer_load_dwordx4 v4, s[56:59], s90 offen offset:0 lds
    ds_read_b128 v[136:139], v10 offset:0
    ds_read_b128 v[140:143], v10 offset:512
    ds_read_b64_tr_b16 v[84:85], v12 offset:6144
    ds_read_b64_tr_b16 v[86:87], v12 offset:6912
    ds_read_b64_tr_b16 v[88:89], v12 offset:6176
    ds_read_b64_tr_b16 v[90:91], v12 offset:6944
    ds_read_b64_tr_b16 v[92:93], v12 offset:6208
    ds_read_b64_tr_b16 v[94:95], v12 offset:6976
    s_waitcnt lgkmcnt(8)
    buffer_load_dwordx4 v5, s[56:59], s90 offen offset:1024 lds
    v_mfma_f32_16x16x32_bf16 v[24:27], v[128:131], v[72:75], v[24:27]
    v_mfma_f32_16x16x32_bf16 v[28:31], v[128:131], v[76:79], v[28:31]
    v_mfma_f32_16x16x32_bf16 v[32:35], v[128:131], v[80:83], v[32:35]
    v_mfma_f32_16x16x32_bf16 v[36:39], v[132:135], v[72:75], v[36:39]
    v_mfma_f32_16x16x32_bf16 v[40:43], v[132:135], v[76:79], v[40:43]
    v_mfma_f32_16x16x32_bf16 v[44:47], v[132:135], v[80:83], v[44:47]
    buffer_load_dwordx4 v6, s[56:59], s90 offen offset:2048 lds
    s_cmp_eq_u32 s88, 10
    s_cselect_b32 s88, 0, s88
    s_waitcnt vmcnt(13) lgkmcnt(0)
    s_barrier
    ds_read_b128 v[144:147], v9 offset:20480
    ds_read_b128 v[148:151], v9 offset:20992
    ds_read_b64_tr_b16 v[72:73], v12 offset:20480
    ds_read_b64_tr_b16 v[74:75], v12 offset:21248
    ds_read_b64_tr_b16 v[76:77], v12 offset:20512
    ds_read_b64_tr_b16 v[78:79], v12 offset:21280
    ds_read_b64_tr_b16 v[80:81], v12 offset:20544
    ds_read_b64_tr_b16 v[82:83], v12 offset:21312
    s_lshl_b32 s89, s88, 7
    s_add_u32 s89, s89, s94
    s_add_u32 m0, s3, 40960
    s_nop 0
    buffer_load_dwordx4 v2, s[52:55], s89 offen lds
    buffer_load_dwordx4 v3, s[52:55], s89 offen offset:1024 lds
    v_mfma_f32_16x16x32_bf16 v[24:27], v[136:139], v[84:87], v[24:27]
    v_mfma_f32_16x16x32_bf16 v[28:31], v[136:139], v[88:91], v[28:31]
    v_mfma_f32_16x16x32_bf16 v[32:35], v[136:139], v[92:95], v[32:35]
    v_mfma_f32_16x16x32_bf16 v[36:39], v[140:143], v[84:87], v[36:39]
    v_mfma_f32_16x16x32_bf16 v[40:43], v[140:143], v[88:91], v[40:43]
    v_mfma_f32_16x16x32_bf16 v[44:47], v[140:143], v[92:95], v[44:47]
    s_mul_i32 s90, s88, 196608
    s_add_u32 s90, s90, s95
    s_add_u32 m0, s4, 40960
    s_add_u32 s88, s88, 1
    buffer_load_dwordx4 v4, s[56:59], s90 offen offset:0 lds
    ds_read_b128 v[152:155], v10 offset:20480
    ds_read_b128 v[156:159], v10 offset:20992
    ds_read_b64_tr_b16 v[84:85], v12 offset:26624
    ds_read_b64_tr_b16 v[86:87], v12 offset:27392
    ds_read_b64_tr_b16 v[88:89], v12 offset:26656
    ds_read_b64_tr_b16 v[90:91], v12 offset:27424
    ds_read_b64_tr_b16 v[92:93], v12 offset:26688
    ds_read_b64_tr_b16 v[94:95], v12 offset:27456
    s_waitcnt lgkmcnt(8)
    buffer_load_dwordx4 v5, s[56:59], s90 offen offset:1024 lds
    v_mfma_f32_16x16x32_bf16 v[24:27], v[144:147], v[72:75], v[24:27]
    v_mfma_f32_16x16x32_bf16 v[28:31], v[144:147], v[76:79], v[28:31]
    v_mfma_f32_16x16x32_bf16 v[32:35], v[144:147], v[80:83], v[32:35]
    v_mfma_f32_16x16x32_bf16 v[36:39], v[148:151], v[72:75], v[36:39]
    v_mfma_f32_16x16x32_bf16 v[40:43], v[148:151], v[76:79], v[40:43]
    v_mfma_f32_16x16x32_bf16 v[44:47], v[148:151], v[80:83], v[44:47]
    buffer_load_dwordx4 v6, s[56:59], s90 offen offset:2048 lds
    s_cmp_eq_u32 s88, 10
    s_cselect_b32 s88, 0, s88
    s_waitcnt vmcnt(10) lgkmcnt(0)
    s_barrier
    v_readfirstlane_b32 s80, v15
    s_nop 3
    s_add_u32 s80, s80, 1
    s_cmp_lg_u32 s81, 0
    s_cbranch_scc1 L_fu3_skip
    s_mov_b32 s91, s10
    s_lshl_b32 s91, s91, 5
    s_add_u32 s91, s91, s82
    s_lshl_b32 s91, s91, 2
    s_add_u32 s91, s91, 8192
    v_mov_b32 v16, s80
    s_mov_b64 s[12:13], exec
    s_mov_b64 exec, 1
    buffer_store_dword v16, off, s[68:71], s91 sc1
    s_mov_b64 exec, s[12:13]
L_fu3_skip:
    ds_read_b128 v[160:163], v7 offset:0
    ds_read_b128 v[164:167], v7 offset:512
    ds_read_b64_tr_b16 v[72:73], v11 offset:0
    ds_read_b64_tr_b16 v[74:75], v11 offset:768
    ds_read_b64_tr_b16 v[76:77], v11 offset:32
    ds_read_b64_tr_b16 v[78:79], v11 offset:800
    ds_read_b64_tr_b16 v[80:81], v11 offset:64
    ds_read_b64_tr_b16 v[82:83], v11 offset:832
    s_lshl_b32 s89, s88, 7
    s_add_u32 s89, s89, s94
    s_add_u32 m0, s3, 61440
    s_nop 0
    buffer_load_dwordx4 v2, s[52:55], s89 offen lds
    buffer_load_dwordx4 v3, s[52:55], s89 offen offset:1024 lds
    v_mfma_f32_16x16x32_bf16 v[24:27], v[152:155], v[84:87], v[24:27]
    v_mfma_f32_16x16x32_bf16 v[28:31], v[152:155], v[88:91], v[28:31]
    v_mfma_f32_16x16x32_bf16 v[32:35], v[152:155], v[92:95], v[32:35]
    v_mfma_f32_16x16x32_bf16 v[36:39], v[156:159], v[84:87], v[36:39]
    v_mfma_f32_16x16x32_bf16 v[40:43], v[156:159], v[88:91], v[40:43]
    v_mfma_f32_16x16x32_bf16 v[44:47], v[156:159], v[92:95], v[44:47]
    s_mul_i32 s90, s88, 196608
    s_add_u32 s90, s90, s95
    s_add_u32 m0, s4, 61440
    s_add_u32 s88, s88, 1
    buffer_load_dwordx4 v4, s[56:59], s90 offen offset:0 lds
    ds_read_b128 v[168:171], v8 offset:0
    ds_read_b128 v[172:175], v8 offset:512
    ds_read_b64_tr_b16 v[84:85], v11 offset:6144
    ds_read_b64_tr_b16 v[86:87], v11 offset:6912
    ds_read_b64_tr_b16 v[88:89], v11 offset:6176
    ds_read_b64_tr_b16 v[90:91], v11 offset:6944
    ds_read_b64_tr_b16 v[92:93], v11 offset:6208
    ds_read_b64_tr_b16 v[94:95], v11 offset:6976
    s_cmp_ge_u32 s83, 2
    s_cbranch_scc1 L_ut2_skip
    ds_read_b64_tr_b16 v[16:17], v13 offset:0
    ds_read_b64_tr_b16 v[18:19], v13 offset:512
    ds_read_b64_tr_b16 v[20:21], v13 offset:4096
    ds_read_b64_tr_b16 v[22:23], v13 offset:4608
L_ut2_skip:
    s_waitcnt lgkmcnt(8)
    buffer_load_dwordx4 v5, s[56:59], s90 offen offset:1024 lds
    v_mfma_f32_16x16x32_bf16 v[24:27], v[160:163], v[72:75], v[24:27]
    v_mfma_f32_16x16x32_bf16 v[28:31], v[160:163], v[76:79], v[28:31]
    v_mfma_f32_16x16x32_bf16 v[32:35], v[160:163], v[80:83], v[32:35]
    v_mfma_f32_16x16x32_bf16 v[36:39], v[164:167], v[72:75], v[36:39]
    v_mfma_f32_16x16x32_bf16 v[40:43], v[164:167], v[76:79], v[40:43]
    v_mfma_f32_16x16x32_bf16 v[44:47], v[164:167], v[80:83], v[44:47]
    buffer_load_dwordx4 v6, s[56:59], s90 offen offset:2048 lds
    s_cmp_eq_u32 s88, 10
    s_cselect_b32 s88, 0, s88
    s_waitcnt vmcnt(10) lgkmcnt(0)
    s_barrier
    s_cmp_ge_u32 s83, 2
    s_cbranch_scc1 L_us2_skip
    s_add_u32 s91, s10, 4
    s_sub_u32 s92, s91, 10
    s_min_u32 s91, s91, s92
    s_lshl_b32 s91, s91, 18
    s_lshl_b32 s92, s82, 7
    s_add_u32 s91, s91, s92
    s_add_u32 s91, s91, 7340032
    buffer_store_dwordx4 v[16:19], v14, s[68:71], s91 offen offset:0 sc1
    buffer_store_dwordx4 v[20:23], v14, s[68:71], s91 offen offset:64 sc1
L_us2_skip:
    ds_read_b128 v[176:179], v7 offset:20480
    ds_read_b128 v[180:183], v7 offset:20992
    ds_read_b64_tr_b16 v[72:73], v11 offset:20480
    ds_read_b64_tr_b16 v[74:75], v11 offset:21248
    ds_read_b64_tr_b16 v[76:77], v11 offset:20512
    ds_read_b64_tr_b16 v[78:79], v11 offset:21280
    ds_read_b64_tr_b16 v[80:81], v11 offset:20544
    ds_read_b64_tr_b16 v[82:83], v11 offset:21312
    s_lshl_b32 s89, s88, 7
    s_add_u32 s89, s89, s94
    s_add_u32 m0, s3, 0
    s_nop 0
    buffer_load_dwordx4 v2, s[52:55], s89 offen lds
    buffer_load_dwordx4 v3, s[52:55], s89 offen offset:1024 lds
    v_mfma_f32_16x16x32_bf16 v[24:27], v[168:171], v[84:87], v[24:27]
    v_mfma_f32_16x16x32_bf16 v[28:31], v[168:171], v[88:91], v[28:31]
    v_mfma_f32_16x16x32_bf16 v[32:35], v[168:171], v[92:95], v[32:35]
    v_mfma_f32_16x16x32_bf16 v[36:39], v[172:175], v[84:87], v[36:39]
    v_mfma_f32_16x16x32_bf16 v[40:43], v[172:175], v[88:91], v[40:43]
    v_mfma_f32_16x16x32_bf16 v[44:47], v[172:175], v[92:95], v[44:47]
    s_mul_i32 s90, s88, 196608
    s_add_u32 s90, s90, s95
    s_add_u32 m0, s4, 0
    s_add_u32 s88, s88, 1
    buffer_load_dwordx4 v4, s[56:59], s90 offen offset:0 lds
    ds_read_b128 v[184:187], v8 offset:20480
    ds_read_b128 v[188:191], v8 offset:20992
    ds_read_b64_tr_b16 v[84:85], v11 offset:26624
    ds_read_b64_tr_b16 v[86:87], v11 offset:27392
    ds_read_b64_tr_b16 v[88:89], v11 offset:26656
    ds_read_b64_tr_b16 v[90:91], v11 offset:27424
    ds_read_b64_tr_b16 v[92:93], v11 offset:26688
    ds_read_b64_tr_b16 v[94:95], v11 offset:27456
    s_waitcnt lgkmcnt(8)
    buffer_load_dwordx4 v5, s[56:59], s90 offen offset:1024 lds
    v_mfma_f32_16x16x32_bf16 v[24:27], v[176:179], v[72:75], v[24:27]
    v_mfma_f32_16x16x32_bf16 v[28:31], v[176:179], v[76:79], v[28:31]
    v_mfma_f32_16x16x32_bf16 v[32:35], v[176:179], v[80:83], v[32:35]
    v_mfma_f32_16x16x32_bf16 v[36:39], v[180:183], v[72:75], v[36:39]
    v_mfma_f32_16x16x32_bf16 v[40:43], v[180:183], v[76:79], v[40:43]
    v_mfma_f32_16x16x32_bf16 v[44:47], v[180:183], v[80:83], v[44:47]
    buffer_load_dwordx4 v6, s[56:59], s90 offen offset:2048 lds
    s_cmp_eq_u32 s88, 10
    s_cselect_b32 s88, 0, s88
    s_waitcnt vmcnt(10) lgkmcnt(0)
    s_barrier
    ds_read_b128 v[192:195], v9 offset:0
    ds_read_b128 v[196:199], v9 offset:512
    ds_read_b64_tr_b16 v[72:73], v12 offset:0
    ds_read_b64_tr_b16 v[74:75], v12 offset:768
    ds_read_b64_tr_b16 v[76:77], v12 offset:32
    ds_read_b64_tr_b16 v[78:79], v12 offset:800
    ds_read_b64_tr_b16 v[80:81], v12 offset:64
    ds_read_b64_tr_b16 v[82:83], v12 offset:832
    s_lshl_b32 s89, s88, 7
    s_add_u32 s89, s89, s94
    s_add_u32 m0, s3, 20480
    s_nop 0
    buffer_load_dwordx4 v2, s[52:55], s89 offen lds
    buffer_load_dwordx4 v3, s[52:55], s89 offen offset:1024 lds
    v_mfma_f32_16x16x32_bf16 v[24:27], v[184:187], v[84:87], v[24:27]
    v_mfma_f32_16x16x32_bf16 v[28:31], v[184:187], v[88:91], v[28:31]
    v_mfma_f32_16x16x32_bf16 v[32:35], v[184:187], v[92:95], v[32:35]
    v_mfma_f32_16x16x32_bf16 v[36:39], v[188:191], v[84:87], v[36:39]
    v_mfma_f32_16x16x32_bf16 v[40:43], v[188:191], v[88:91], v[40:43]
    v_mfma_f32_16x16x32_bf16 v[44:47], v[188:191], v[92:95], v[44:47]
    s_mul_i32 s90, s88, 196608
    s_add_u32 s90, s90, s95
    s_add_u32 m0, s4, 20480
    s_add_u32 s88, s88, 1
    buffer_load_dwordx4 v4, s[56:59], s90 offen offset:0 lds
    ds_read_b128 v[200:203], v10 offset:0
    ds_read_b128 v[204:207], v10 offset:512
    ds_read_b64_tr_b16 v[84:85], v12 offset:6144
    ds_read_b64_tr_b16 v[86:87], v12 offset:6912
    ds_read_b64_tr_b16 v[88:89], v12 offset:6176
    ds_read_b64_tr_b16 v[90:91], v12 offset:6944
    ds_read_b64_tr_b16 v[92:93], v12 offset:6208
    ds_read_b64_tr_b16 v[94:95], v12 offset:6976
    s_waitcnt lgkmcnt(8)
    buffer_load_dwordx4 v5, s[56:59], s90 offen offset:1024 lds
    v_mfma_f32_16x16x32_bf16 v[24:27], v[192:195], v[72:75], v[24:27]
    v_mfma_f32_16x16x32_bf16 v[28:31], v[192:195], v[76:79], v[28:31]
    v_mfma_f32_16x16x32_bf16 v[32:35], v[192:195], v[80:83], v[32:35]
    v_mfma_f32_16x16x32_bf16 v[36:39], v[196:199], v[72:75], v[36:39]
    v_mfma_f32_16x16x32_bf16 v[40:43], v[196:199], v[76:79], v[40:43]
    v_mfma_f32_16x16x32_bf16 v[44:47], v[196:199], v[80:83], v[44:47]
    buffer_load_dwordx4 v6, s[56:59], s90 offen offset:2048 lds
    s_cmp_eq_u32 s88, 10
    s_cselect_b32 s88, 0, s88
    s_sub_u32 s95, s95, 1536
    s_waitcnt vmcnt(10) lgkmcnt(0)
    s_barrier
    ds_read_b128 v[208:211], v9 offset:20480
    ds_read_b128 v[212:215], v9 offset:20992
    ds_read_b64_tr_b16 v[72:73], v12 offset:20480
    ds_read_b64_tr_b16 v[74:75], v12 offset:21248
    ds_read_b64_tr_b16 v[76:77], v12 offset:20512
    ds_read_b64_tr_b16 v[78:79], v12 offset:21280
    ds_read_b64_tr_b16 v[80:81], v12 offset:20544
    ds_read_b64_tr_b16 v[82:83], v12 offset:21312
    s_mul_i32 s90, s88, 196608
    s_add_u32 s90, s90, s95
    s_add_u32 m0, s4, 40960
    s_add_u32 s88, s88, 1
    buffer_load_dwordx4 v4, s[56:59], s90 offen offset:0 lds
    v_mfma_f32_16x16x32_bf16 v[24:27], v[200:203], v[84:87], v[24:27]
    v_mfma_f32_16x16x32_bf16 v[28:31], v[200:203], v[88:91], v[28:31]
    v_mfma_f32_16x16x32_bf16 v[32:35], v[200:203], v[92:95], v[32:35]
    v_mfma_f32_16x16x32_bf16 v[36:39], v[204:207], v[84:87], v[36:39]
    v_mfma_f32_16x16x32_bf16 v[40:43], v[204:207], v[88:91], v[40:43]
    v_mfma_f32_16x16x32_bf16 v[44:47], v[204:207], v[92:95], v[44:47]
    buffer_load_dwordx4 v5, s[56:59], s90 offen offset:1024 lds
    ds_read_b128 v[216:219], v10 offset:20480
    ds_read_b128 v[220:223], v10 offset:20992
    ds_read_b64_tr_b16 v[84:85], v12 offset:26624
    ds_read_b64_tr_b16 v[86:87], v12 offset:27392
    ds_read_b64_tr_b16 v[88:89], v12 offset:26656
    ds_read_b64_tr_b16 v[90:91], v12 offset:27424
    ds_read_b64_tr_b16 v[92:93], v12 offset:26688
    ds_read_b64_tr_b16 v[94:95], v12 offset:27456
    s_waitcnt lgkmcnt(8)
    v_mfma_f32_16x16x32_bf16 v[24:27], v[208:211], v[72:75], v[24:27]
    v_mfma_f32_16x16x32_bf16 v[28:31], v[208:211], v[76:79], v[28:31]
    v_mfma_f32_16x16x32_bf16 v[32:35], v[208:211], v[80:83], v[32:35]
    v_mfma_f32_16x16x32_bf16 v[36:39], v[212:215], v[72:75], v[36:39]
    v_mfma_f32_16x16x32_bf16 v[40:43], v[212:215], v[76:79], v[40:43]
    v_mfma_f32_16x16x32_bf16 v[44:47], v[212:215], v[80:83], v[44:47]
    buffer_load_dwordx4 v6, s[56:59], s90 offen offset:2048 lds
    s_cmp_eq_u32 s88, 10
    s_cselect_b32 s88, 0, s88
    s_waitcnt vmcnt(8) lgkmcnt(0)
    s_barrier
    s_cmp_lg_u32 s81, 0
    s_cbranch_scc1 L_fu7_skip
    s_cmp_ge_u32 s83, 2
    s_cbranch_scc1 L_fu7_skip
    s_add_u32 s91, s10, 4
    s_sub_u32 s92, s91, 10
    s_min_u32 s91, s91, s92
    s_lshl_b32 s91, s91, 5
    s_add_u32 s91, s91, s82
    s_lshl_b32 s91, s91, 2
    s_add_u32 s91, s91, 8192
    v_mov_b32 v16, s80
    s_mov_b64 s[12:13], exec
    s_mov_b64 exec, 1
    buffer_store_dword v16, off, s[68:71], s91 sc1
    s_mov_b64 exec, s[12:13]
L_fu7_skip:
    ds_read_b128 v[224:227], v7 offset:0
    ds_read_b128 v[228:231], v7 offset:512
    ds_read_b64_tr_b16 v[72:73], v11 offset:0
    ds_read_b64_tr_b16 v[74:75], v11 offset:768
    ds_read_b64_tr_b16 v[76:77], v11 offset:32
    ds_read_b64_tr_b16 v[78:79], v11 offset:800
    ds_read_b64_tr_b16 v[80:81], v11 offset:64
    ds_read_b64_tr_b16 v[82:83], v11 offset:832
    s_mul_i32 s90, s88, 196608
    s_add_u32 s90, s90, s95
    s_add_u32 m0, s4, 61440
    s_add_u32 s88, s88, 1
    buffer_load_dwordx4 v4, s[56:59], s90 offen offset:0 lds
    v_mfma_f32_16x16x32_bf16 v[24:27], v[216:219], v[84:87], v[24:27]
    v_mfma_f32_16x16x32_bf16 v[28:31], v[216:219], v[88:91], v[28:31]
    v_mfma_f32_16x16x32_bf16 v[32:35], v[216:219], v[92:95], v[32:35]
    v_mfma_f32_16x16x32_bf16 v[36:39], v[220:223], v[84:87], v[36:39]
    v_mfma_f32_16x16x32_bf16 v[40:43], v[220:223], v[88:91], v[40:43]
    v_mfma_f32_16x16x32_bf16 v[44:47], v[220:223], v[92:95], v[44:47]
    buffer_load_dwordx4 v5, s[56:59], s90 offen offset:1024 lds
    ds_read_b128 v[232:235], v8 offset:0
    ds_read_b128 v[236:239], v8 offset:512
    ds_read_b64_tr_b16 v[84:85], v11 offset:6144
    ds_read_b64_tr_b16 v[86:87], v11 offset:6912
    ds_read_b64_tr_b16 v[88:89], v11 offset:6176
    ds_read_b64_tr_b16 v[90:91], v11 offset:6944
    ds_read_b64_tr_b16 v[92:93], v11 offset:6208
    ds_read_b64_tr_b16 v[94:95], v11 offset:6976
    s_waitcnt lgkmcnt(8)
    v_mfma_f32_16x16x32_bf16 v[24:27], v[224:227], v[72:75], v[24:27]
    v_mfma_f32_16x16x32_bf16 v[28:31], v[224:227], v[76:79], v[28:31]
    v_mfma_f32_16x16x32_bf16 v[32:35], v[224:227], v[80:83], v[32:35]
    v_mfma_f32_16x16x32_bf16 v[36:39], v[228:231], v[72:75], v[36:39]
    v_mfma_f32_16x16x32_bf16 v[40:43], v[228:231], v[76:79], v[40:43]
    v_mfma_f32_16x16x32_bf16 v[44:47], v[228:231], v[80:83], v[44:47]
    buffer_load_dwordx4 v6, s[56:59], s90 offen offset:2048 lds
    s_cmp_eq_u32 s88, 10
    s_cselect_b32 s88, 0, s88
    s_waitcnt vmcnt(6) lgkmcnt(0)
    s_barrier
    ds_read_b128 v[240:243], v7 offset:20480
    ds_read_b128 v[244:247], v7 offset:20992
    ds_read_b64_tr_b16 v[72:73], v11 offset:20480
    ds_read_b64_tr_b16 v[74:75], v11 offset:21248
    ds_read_b64_tr_b16 v[76:77], v11 offset:20512
    ds_read_b64_tr_b16 v[78:79], v11 offset:21280
    ds_read_b64_tr_b16 v[80:81], v11 offset:20544
    ds_read_b64_tr_b16 v[82:83], v11 offset:21312
    s_mul_i32 s90, s88, 196608
    s_add_u32 s90, s90, s95
    s_add_u32 m0, s4, 0
    s_add_u32 s88, s88, 1
    buffer_load_dwordx4 v4, s[56:59], s90 offen offset:0 lds
    v_mfma_f32_16x16x32_bf16 v[24:27], v[232:235], v[84:87], v[24:27]
    v_mfma_f32_16x16x32_bf16 v[28:31], v[232:235], v[88:91], v[28:31]
    v_mfma_f32_16x16x32_bf16 v[32:35], v[232:235], v[92:95], v[32:35]
    v_mfma_f32_16x16x32_bf16 v[36:39], v[236:239], v[84:87], v[36:39]
    v_mfma_f32_16x16x32_bf16 v[40:43], v[236:239], v[88:91], v[40:43]
    v_mfma_f32_16x16x32_bf16 v[44:47], v[236:239], v[92:95], v[44:47]
    buffer_load_dwordx4 v5, s[56:59], s90 offen offset:1024 lds
    ds_read_b128 v[248:251], v8 offset:20480
    ds_read_b128 v[252:255], v8 offset:20992
    ds_read_b64_tr_b16 v[84:85], v11 offset:26624
    ds_read_b64_tr_b16 v[86:87], v11 offset:27392
    ds_read_b64_tr_b16 v[88:89], v11 offset:26656
    ds_read_b64_tr_b16 v[90:91], v11 offset:27424
    ds_read_b64_tr_b16 v[92:93], v11 offset:26688
    ds_read_b64_tr_b16 v[94:95], v11 offset:27456
    s_waitcnt lgkmcnt(8)
    v_mfma_f32_16x16x32_bf16 v[24:27], v[240:243], v[72:75], v[24:27]
    v_mfma_f32_16x16x32_bf16 v[28:31], v[240:243], v[76:79], v[28:31]
    v_mfma_f32_16x16x32_bf16 v[32:35], v[240:243], v[80:83], v[32:35]
    v_mfma_f32_16x16x32_bf16 v[36:39], v[244:247], v[72:75], v[36:39]
    v_mfma_f32_16x16x32_bf16 v[40:43], v[244:247], v[76:79], v[40:43]
    v_mfma_f32_16x16x32_bf16 v[44:47], v[244:247], v[80:83], v[44:47]
    buffer_load_dwordx4 v6, s[56:59], s90 offen offset:2048 lds
    s_cmp_eq_u32 s88, 10
    s_cselect_b32 s88, 0, s88
    s_waitcnt vmcnt(6) lgkmcnt(0)
    s_barrier
    ds_read_b64_tr_b16 v[72:73], v12 offset:0
    ds_read_b64_tr_b16 v[74:75], v12 offset:768
    ds_read_b64_tr_b16 v[76:77], v12 offset:32
    ds_read_b64_tr_b16 v[78:79], v12 offset:800
    ds_read_b64_tr_b16 v[80:81], v12 offset:64
    ds_read_b64_tr_b16 v[82:83], v12 offset:832
    s_mul_i32 s90, s88, 196608
    s_add_u32 s90, s90, s95
    s_add_u32 m0, s4, 20480
    s_add_u32 s88, s88, 1
    buffer_load_dwordx4 v4, s[56:59], s90 offen offset:0 lds
    v_mfma_f32_16x16x32_bf16 v[24:27], v[248:251], v[84:87], v[24:27]
    v_mfma_f32_16x16x32_bf16 v[28:31], v[248:251], v[88:91], v[28:31]
    v_mfma_f32_16x16x32_bf16 v[32:35], v[248:251], v[92:95], v[32:35]
    v_mfma_f32_16x16x32_bf16 v[36:39], v[252:255], v[84:87], v[36:39]
    v_mfma_f32_16x16x32_bf16 v[40:43], v[252:255], v[88:91], v[40:43]
    v_mfma_f32_16x16x32_bf16 v[44:47], v[252:255], v[92:95], v[44:47]
    buffer_load_dwordx4 v5, s[56:59], s90 offen offset:1024 lds
    buffer_load_dwordx4 v6, s[56:59], s90 offen offset:2048 lds
    s_cmp_eq_u32 s88, 10
    s_cselect_b32 s88, 0, s88
    v_mov_b32 v64, 0xc0135761
    v_mov_b32 v65, 0xc0135761
    v_cvt_pk_bf16_f32 v18, v24, v25
    v_cvt_pk_bf16_f32 v22, v26, v27
    v_lshlrev_b32 v16, 16, v18
    v_lshlrev_b32 v20, 16, v22
    v_and_b32 v17, 0xffff0000, v18
    v_and_b32 v21, 0xffff0000, v22
    v_pk_mul_f32 v[18:19], v[16:17], v[16:17]
    v_pk_mul_f32 v[22:23], v[20:21], v[20:21]
    v_pk_fma_f32 v[18:19], v[18:19], s[6:7], v[64:65]
    v_pk_fma_f32 v[22:23], v[22:23], s[6:7], v[64:65]
    v_pk_mul_f32 v[18:19], v[18:19], v[16:17]
    v_pk_mul_f32 v[22:23], v[22:23], v[20:21]
    v_exp_f32 v18, v18
    v_exp_f32 v22, v22
    v_exp_f32 v19, v19
    v_exp_f32 v23, v23
    s_nop 0
    v_pk_add_f32 v[18:19], v[18:19], s[8:9]
    v_pk_add_f32 v[22:23], v[22:23], s[8:9]
    v_rcp_f32 v18, v18
    v_rcp_f32 v22, v22
    v_rcp_f32 v19, v19
    v_rcp_f32 v23, v23
    s_nop 0
    v_pk_mul_f32 v[18:19], v[18:19], v[16:17]
    v_pk_mul_f32 v[22:23], v[22:23], v[20:21]
    v_cvt_pk_bf16_f32 v24, v18, v19
    v_cvt_pk_bf16_f32 v26, v22, v23
    v_lshlrev_b32 v48, 16, v24
    v_lshlrev_b32 v50, 16, v26
    v_and_b32 v49, 0xffff0000, v24
    v_and_b32 v51, 0xffff0000, v26
    v_pk_mul_f32 v[56:57], v[48:49], v[48:49]
    v_pk_mul_f32 v[58:59], v[50:51], v[50:51]
    v_cvt_pk_bf16_f32 v18, v36, v37
    v_cvt_pk_bf16_f32 v22, v38, v39
    v_lshlrev_b32 v16, 16, v18
    v_lshlrev_b32 v20, 16, v22
    v_and_b32 v17, 0xffff0000, v18
    v_and_b32 v21, 0xffff0000, v22
    v_pk_mul_f32 v[18:19], v[16:17], v[16:17]
    v_pk_mul_f32 v[22:23], v[20:21], v[20:21]
    v_pk_fma_f32 v[18:19], v[18:19], s[6:7], v[64:65]
    v_pk_fma_f32 v[22:23], v[22:23], s[6:7], v[64:65]
    v_pk_mul_f32 v[18:19], v[18:19], v[16:17]
    v_pk_mul_f32 v[22:23], v[22:23], v[20:21]
    v_exp_f32 v18, v18
    v_exp_f32 v22, v22
    v_exp_f32 v19, v19
    v_exp_f32 v23, v23
    s_nop 0
    v_pk_add_f32 v[18:19], v[18:19], s[8:9]
    v_pk_add_f32 v[22:23], v[22:23], s[8:9]
    v_rcp_f32 v18, v18
    v_rcp_f32 v22, v22
    v_rcp_f32 v19, v19
    v_rcp_f32 v23, v23
    s_nop 0
    v_pk_mul_f32 v[18:19], v[18:19], v[16:17]
    v_pk_mul_f32 v[22:23], v[22:23], v[20:21]
    v_cvt_pk_bf16_f32 v36, v18, v19
    v_cvt_pk_bf16_f32 v38, v22, v23
    v_lshlrev_b32 v52, 16, v36
    v_lshlrev_b32 v54, 16, v38
    v_and_b32 v53, 0xffff0000, v36
    v_and_b32 v55, 0xffff0000, v38
    v_pk_mul_f32 v[60:61], v[52:53], v[52:53]
    v_pk_mul_f32 v[62:63], v[54:55], v[54:55]
    v_cvt_pk_bf16_f32 v18, v28, v29
    v_cvt_pk_bf16_f32 v22, v30, v31
    v_lshlrev_b32 v16, 16, v18
    v_lshlrev_b32 v20, 16, v22
    v_and_b32 v17, 0xffff0000, v18
    v_and_b32 v21, 0xffff0000, v22
    v_pk_mul_f32 v[18:19], v[16:17], v[16:17]
    v_pk_mul_f32 v[22:23], v[20:21], v[20:21]
    v_pk_fma_f32 v[18:19], v[18:19], s[6:7], v[64:65]
    v_pk_fma_f32 v[22:23], v[22:23], s[6:7], v[64:65]
    v_pk_mul_f32 v[18:19], v[18:19], v[16:17]
    v_pk_mul_f32 v[22:23], v[22:23], v[20:21]
    v_exp_f32 v18, v18
    v_exp_f32 v22, v22
    v_exp_f32 v19, v19
    v_exp_f32 v23, v23
    s_nop 0
    v_pk_add_f32 v[18:19], v[18:19], s[8:9]
    v_pk_add_f32 v[22:23], v[22:23], s[8:9]
    v_rcp_f32 v18, v18
    v_rcp_f32 v22, v22
    v_rcp_f32 v19, v19
    v_rcp_f32 v23, v23
    s_nop 0
    v_pk_mul_f32 v[18:19], v[18:19], v[16:17]
    v_pk_mul_f32 v[22:23], v[22:23], v[20:21]
    v_cvt_pk_bf16_f32 v28, v18, v19
    v_cvt_pk_bf16_f32 v30, v22, v23
    v_lshlrev_b32 v16, 16, v28
    v_lshlrev_b32 v20, 16, v30
    v_and_b32 v17, 0xffff0000, v28
    v_and_b32 v21, 0xffff0000, v30
    v_pk_add_f32 v[48:49], v[48:49], v[16:17]
    v_pk_add_f32 v[50:51], v[50:51], v[20:21]
    v_pk_fma_f32 v[56:57], v[16:17], v[16:17], v[56:57]
    v_pk_fma_f32 v[58:59], v[20:21], v[20:21], v[58:59]
    v_cvt_pk_bf16_f32 v18, v40, v41
    v_cvt_pk_bf16_f32 v22, v42, v43
    v_lshlrev_b32 v16, 16, v18
    v_lshlrev_b32 v20, 16, v22
    v_and_b32 v17, 0xffff0000, v18
    v_and_b32 v21, 0xffff0000, v22
    v_pk_mul_f32 v[18:19], v[16:17], v[16:17]
    v_pk_mul_f32 v[22:23], v[20:21], v[20:21]
    v_pk_fma_f32 v[18:19], v[18:19], s[6:7], v[64:65]
    v_pk_fma_f32 v[22:23], v[22:23], s[6:7], v[64:65]
    v_pk_mul_f32 v[18:19], v[18:19], v[16:17]
    v_pk_mul_f32 v[22:23], v[22:23], v[20:21]
    v_exp_f32 v18, v18
    v_exp_f32 v22, v22
    v_exp_f32 v19, v19
    v_exp_f32 v23, v23
    s_nop 0
    v_pk_add_f32 v[18:19], v[18:19], s[8:9]
    v_pk_add_f32 v[22:23], v[22:23], s[8:9]
    v_rcp_f32 v18, v18
    v_rcp_f32 v22, v22
    v_rcp_f32 v19, v19
    v_rcp_f32 v23, v23
    s_nop 0
    v_pk_mul_f32 v[18:19], v[18:19], v[16:17]
    v_pk_mul_f32 v[22:23], v[22:23], v[20:21]
    v_cvt_pk_bf16_f32 v40, v18, v19
    v_cvt_pk_bf16_f32 v42, v22, v23
    v_lshlrev_b32 v16, 16, v40
    v_lshlrev_b32 v20, 16, v42
    v_and_b32 v17, 0xffff0000, v40
    v_and_b32 v21, 0xffff0000, v42
    v_pk_add_f32 v[52:53], v[52:53], v[16:17]
    v_pk_add_f32 v[54:55], v[54:55], v[20:21]
    v_pk_fma_f32 v[60:61], v[16:17], v[16:17], v[60:61]
    v_pk_fma_f32 v[62:63], v[20:21], v[20:21], v[62:63]
    v_cvt_pk_bf16_f32 v18, v32, v33
    v_cvt_pk_bf16_f32 v22, v34, v35
    v_lshlrev_b32 v16, 16, v18
    v_lshlrev_b32 v20, 16, v22
    v_and_b32 v17, 0xffff0000, v18
    v_and_b32 v21, 0xffff0000, v22
    v_pk_mul_f32 v[18:19], v[16:17], v[16:17]
    v_pk_mul_f32 v[22:23], v[20:21], v[20:21]
    v_pk_fma_f32 v[18:19], v[18:19], s[6:7], v[64:65]
    v_pk_fma_f32 v[22:23], v[22:23], s[6:7], v[64:65]
    v_pk_mul_f32 v[18:19], v[18:19], v[16:17]
    v_pk_mul_f32 v[22:23], v[22:23], v[20:21]
    v_exp_f32 v18, v18
    v_exp_f32 v22, v22
    v_exp_f32 v19, v19
    v_exp_f32 v23, v23
    s_nop 0
    v_pk_add_f32 v[18:19], v[18:19], s[8:9]
    v_pk_add_f32 v[22:23], v[22:23], s[8:9]
    v_rcp_f32 v18, v18
    v_rcp_f32 v22, v22
    v_rcp_f32 v19, v19
    v_rcp_f32 v23, v23
    s_nop 0
    v_pk_mul_f32 v[18:19], v[18:19], v[16:17]
    v_pk_mul_f32 v[22:23], v[22:23], v[20:21]
    v_cvt_pk_bf16_f32 v32, v18, v19
    v_cvt_pk_bf16_f32 v34, v22, v23
    v_lshlrev_b32 v16, 16, v32
    v_lshlrev_b32 v20, 16, v34
    v_and_b32 v17, 0xffff0000, v32
    v_and_b32 v21, 0xffff0000, v34
    v_pk_add_f32 v[48:49], v[48:49], v[16:17]
    v_pk_add_f32 v[50:51], v[50:51], v[20:21]
    v_pk_fma_f32 v[56:57], v[16:17], v[16:17], v[56:57]
    v_pk_fma_f32 v[58:59], v[20:21], v[20:21], v[58:59]
    v_cvt_pk_bf16_f32 v18, v44, v45
    v_cvt_pk_bf16_f32 v22, v46, v47
    v_lshlrev_b32 v16, 16, v18
    v_lshlrev_b32 v20, 16, v22
    v_and_b32 v17, 0xffff0000, v18
    v_and_b32 v21, 0xffff0000, v22
    v_pk_mul_f32 v[18:19], v[16:17], v[16:17]
    v_pk_mul_f32 v[22:23], v[20:21], v[20:21]
    v_pk_fma_f32 v[18:19], v[18:19], s[6:7], v[64:65]
    v_pk_fma_f32 v[22:23], v[22:23], s[6:7], v[64:65]
    v_pk_mul_f32 v[18:19], v[18:19], v[16:17]
    v_pk_mul_f32 v[22:23], v[22:23], v[20:21]
    v_exp_f32 v18, v18
    v_exp_f32 v22, v22
    v_exp_f32 v19, v19
    v_exp_f32 v23, v23
    s_nop 0
    v_pk_add_f32 v[18:19], v[18:19], s[8:9]
    v_pk_add_f32 v[22:23], v[22:23], s[8:9]
    v_rcp_f32 v18, v18
    v_rcp_f32 v22, v22
    v_rcp_f32 v19, v19
    v_rcp_f32 v23, v23
    s_nop 0
    v_pk_mul_f32 v[18:19], v[18:19], v[16:17]
    v_pk_mul_f32 v[22:23], v[22:23], v[20:21]
    v_cvt_pk_bf16_f32 v44, v18, v19
    v_cvt_pk_bf16_f32 v46, v22, v23
    v_lshlrev_b32 v16, 16, v44
    v_lshlrev_b32 v20, 16, v46
    v_and_b32 v17, 0xffff0000, v44
    v_and_b32 v21, 0xffff0000, v46
    v_pk_add_f32 v[52:53], v[52:53], v[16:17]
    v_pk_add_f32 v[54:55], v[54:55], v[20:21]
    v_pk_fma_f32 v[60:61], v[16:17], v[16:17], v[60:61]
    v_pk_fma_f32 v[62:63], v[20:21], v[20:21], v[62:63]
    v_add_f32_dpp v48, v48, v48 row_ror:8 row_mask:0xf bank_mask:0x3
    v_add_f32_dpp v49, v49, v49 row_ror:8 row_mask:0xf bank_mask:0x3
    v_add_f32_dpp v50, v50, v50 row_ror:8 row_mask:0xf bank_mask:0x3
    v_add_f32_dpp v51, v51, v51 row_ror:8 row_mask:0xf bank_mask:0x3
    v_add_f32_dpp v52, v52, v52 row_ror:8 row_mask:0xf bank_mask:0x3
    v_add_f32_dpp v53, v53, v53 row_ror:8 row_mask:0xf bank_mask:0x3
    v_add_f32_dpp v54, v54, v54 row_ror:8 row_mask:0xf bank_mask:0x3
    v_add_f32_dpp v55, v55, v55 row_ror:8 row_mask:0xf bank_mask:0x3
    v_add_f32_dpp v48, v56, v56 row_ror:8 row_mask:0xf bank_mask:0xc
    v_add_f32_dpp v49, v57, v57 row_ror:8 row_mask:0xf bank_mask:0xc
    v_add_f32_dpp v50, v58, v58 row_ror:8 row_mask:0xf bank_mask:0xc
    v_add_f32_dpp v51, v59, v59 row_ror:8 row_mask:0xf bank_mask:0xc
    v_add_f32_dpp v52, v60, v60 row_ror:8 row_mask:0xf bank_mask:0xc
    v_add_f32_dpp v53, v61, v61 row_ror:8 row_mask:0xf bank_mask:0xc
    v_add_f32_dpp v54, v62, v62 row_ror:8 row_mask:0xf bank_mask:0xc
    v_add_f32_dpp v55, v63, v63 row_ror:8 row_mask:0xf bank_mask:0xc
    v_add_f32_dpp v48, v48, v48 row_half_mirror row_mask:0xf bank_mask:0x5
    v_add_f32_dpp v49, v49, v49 row_half_mirror row_mask:0xf bank_mask:0x5
    v_add_f32_dpp v50, v50, v50 row_half_mirror row_mask:0xf bank_mask:0x5
    v_add_f32_dpp v51, v51, v51 row_half_mirror row_mask:0xf bank_mask:0x5
    v_add_f32_dpp v48, v52, v52 row_half_mirror row_mask:0xf bank_mask:0xa
    v_add_f32_dpp v49, v53, v53 row_half_mirror row_mask:0xf bank_mask:0xa
    v_add_f32_dpp v50, v54, v54 row_half_mirror row_mask:0xf bank_mask:0xa
    v_add_f32_dpp v51, v55, v55 row_half_mirror row_mask:0xf bank_mask:0xa
    v_and_b32 v16, 15, v1
    v_lshrrev_b32 v17, 4, v1
    v_and_b32 v18, 3, v1
    v_add_f32_dpp v48, v48, v48 quad_perm:[3,2,1,0] row_mask:0xf bank_mask:0xf
    v_add_f32_dpp v49, v49, v49 quad_perm:[3,2,1,0] row_mask:0xf bank_mask:0xf
    v_add_f32_dpp v50, v50, v50 quad_perm:[3,2,1,0] row_mask:0xf bank_mask:0xf
    v_add_f32_dpp v51, v51, v51 quad_perm:[3,2,1,0] row_mask:0xf bank_mask:0xf
    v_add_f32_dpp v48, v48, v48 quad_perm:[1,0,3,2] row_mask:0xf bank_mask:0xf
    v_add_f32_dpp v49, v49, v49 quad_perm:[1,0,3,2] row_mask:0xf bank_mask:0xf
    v_add_f32_dpp v50, v50, v50 quad_perm:[1,0,3,2] row_mask:0xf bank_mask:0xf
    v_add_f32_dpp v51, v51, v51 quad_perm:[1,0,3,2] row_mask:0xf bank_mask:0xf
    v_cmp_eq_u32 vcc, 1, v18
    v_cmp_eq_u32 s[84:85], 2, v18
    v_cmp_eq_u32 s[12:13], 3, v18
    v_lshl_add_u32 v18, v16, 2, v17
    v_cndmask_b32 v20, v48, v49, vcc
    v_cndmask_b32 v20, v20, v50, s[84:85]
    v_cndmask_b32 v20, v20, v51, s[12:13]
    v_mov_b32 v21, s80
    v_mov_b32 v23, s80
    v_mov_b32_dpp v22, v20 row_ror:8 row_mask:0xf bank_mask:0xf
    s_lshl_b32 s91, s86, 5
    v_add_u32 v18, s91, v18
    v_lshlrev_b32 v18, 8, v18
    s_lshl_b32 s91, s82, 14
    s_lshl_b32 s92, s83, 5
    s_add_u32 s91, s91, s92
    s_lshl_b32 s92, s87, 4
    s_add_u32 s91, s91, s92
    s_add_u32 s91, s91, 65536
    v_cmp_gt_u32 vcc, 8, v16
    s_nop 3
    s_and_saveexec_b64 s[12:13], vcc
    buffer_store_dwordx4 v[20:23], v18, s[68:71], s91 offen sc1
    s_mov_b64 exec, s[12:13]
    ds_read_b64_tr_b16 v[84:85], v12 offset:6144
    ds_read_b64_tr_b16 v[86:87], v12 offset:6912
    ds_read_b64_tr_b16 v[88:89], v12 offset:6176
    ds_read_b64_tr_b16 v[90:91], v12 offset:6944
    ds_read_b64_tr_b16 v[92:93], v12 offset:6208
    ds_read_b64_tr_b16 v[94:95], v12 offset:6976
    s_waitcnt lgkmcnt(6)
    v_mfma_f32_16x16x32_bf16 v[48:51], v[72:75], v[96:99], 0
    v_mfma_f32_16x16x32_bf16 v[56:59], v[76:79], v[96:99], 0
    v_mfma_f32_16x16x32_bf16 v[64:67], v[80:83], v[96:99], 0
    v_mfma_f32_16x16x32_bf16 v[52:55], v[72:75], v[100:103], 0
    v_mfma_f32_16x16x32_bf16 v[60:63], v[76:79], v[100:103], 0
    v_mfma_f32_16x16x32_bf16 v[68:71], v[80:83], v[100:103], 0
    s_waitcnt vmcnt(7) lgkmcnt(0)
    s_barrier
    ds_read_b64_tr_b16 v[72:73], v12 offset:20480
    ds_read_b64_tr_b16 v[74:75], v12 offset:21248
    ds_read_b64_tr_b16 v[76:77], v12 offset:20512
    ds_read_b64_tr_b16 v[78:79], v12 offset:21280
    ds_read_b64_tr_b16 v[80:81], v12 offset:20544
    ds_read_b64_tr_b16 v[82:83], v12 offset:21312
    s_mul_i32 s90, s88, 196608
    s_add_u32 s90, s90, s95
    s_add_u32 m0, s4, 40960
    s_add_u32 s88, s88, 1
    buffer_load_dwordx4 v4, s[56:59], s90 offen offset:0 lds
    v_mfma_f32_16x16x32_bf16 v[48:51], v[84:87], v[104:107], v[48:51]
    v_mfma_f32_16x16x32_bf16 v[56:59], v[88:91], v[104:107], v[56:59]
    v_mfma_f32_16x16x32_bf16 v[64:67], v[92:95], v[104:107], v[64:67]
    v_mfma_f32_16x16x32_bf16 v[52:55], v[84:87], v[108:111], v[52:55]
    v_mfma_f32_16x16x32_bf16 v[60:63], v[88:91], v[108:111], v[60:63]
    v_mfma_f32_16x16x32_bf16 v[68:71], v[92:95], v[108:111], v[68:71]
    buffer_load_dwordx4 v5, s[56:59], s90 offen offset:1024 lds
    ds_read_b64_tr_b16 v[84:85], v12 offset:26624
    ds_read_b64_tr_b16 v[86:87], v12 offset:27392
    ds_read_b64_tr_b16 v[88:89], v12 offset:26656
    ds_read_b64_tr_b16 v[90:91], v12 offset:27424
    ds_read_b64_tr_b16 v[92:93], v12 offset:26688
    ds_read_b64_tr_b16 v[94:95], v12 offset:27456
    s_waitcnt lgkmcnt(6)
    v_mfma_f32_16x16x32_bf16 v[48:51], v[72:75], v[112:115], v[48:51]
    v_mfma_f32_16x16x32_bf16 v[56:59], v[76:79], v[112:115], v[56:59]
    v_mfma_f32_16x16x32_bf16 v[64:67], v[80:83], v[112:115], v[64:67]
    v_mfma_f32_16x16x32_bf16 v[52:55], v[72:75], v[116:119], v[52:55]
    v_mfma_f32_16x16x32_bf16 v[60:63], v[76:79], v[116:119], v[60:63]
    v_mfma_f32_16x16x32_bf16 v[68:71], v[80:83], v[116:119], v[68:71]
    buffer_load_dwordx4 v6, s[56:59], s90 offen offset:2048 lds
    s_cmp_eq_u32 s88, 10
    s_cselect_b32 s88, 0, s88
    s_waitcnt vmcnt(7) lgkmcnt(0)
    s_barrier
    ds_read_b64_tr_b16 v[72:73], v11 offset:0
    ds_read_b64_tr_b16 v[74:75], v11 offset:768
    ds_read_b64_tr_b16 v[76:77], v11 offset:32
    ds_read_b64_tr_b16 v[78:79], v11 offset:800
    ds_read_b64_tr_b16 v[80:81], v11 offset:64
    ds_read_b64_tr_b16 v[82:83], v11 offset:832
    s_mul_i32 s90, s88, 196608
    s_add_u32 s90, s90, s95
    s_add_u32 m0, s4, 61440
    s_add_u32 s88, s88, 1
    buffer_load_dwordx4 v4, s[56:59], s90 offen offset:0 lds
    v_mfma_f32_16x16x32_bf16 v[48:51], v[84:87], v[120:123], v[48:51]
    v_mfma_f32_16x16x32_bf16 v[56:59], v[88:91], v[120:123], v[56:59]
    v_mfma_f32_16x16x32_bf16 v[64:67], v[92:95], v[120:123], v[64:67]
    v_mfma_f32_16x16x32_bf16 v[52:55], v[84:87], v[124:127], v[52:55]
    v_mfma_f32_16x16x32_bf16 v[60:63], v[88:91], v[124:127], v[60:63]
    v_mfma_f32_16x16x32_bf16 v[68:71], v[92:95], v[124:127], v[68:71]
    buffer_load_dwordx4 v5, s[56:59], s90 offen offset:1024 lds
    ds_read_b64_tr_b16 v[84:85], v11 offset:6144
    ds_read_b64_tr_b16 v[86:87], v11 offset:6912
    ds_read_b64_tr_b16 v[88:89], v11 offset:6176
    ds_read_b64_tr_b16 v[90:91], v11 offset:6944
    ds_read_b64_tr_b16 v[92:93], v11 offset:6208
    ds_read_b64_tr_b16 v[94:95], v11 offset:6976
    s_waitcnt lgkmcnt(6)
    v_mfma_f32_16x16x32_bf16 v[48:51], v[72:75], v[128:131], v[48:51]
    v_mfma_f32_16x16x32_bf16 v[56:59], v[76:79], v[128:131], v[56:59]
    v_mfma_f32_16x16x32_bf16 v[64:67], v[80:83], v[128:131], v[64:67]
    v_mfma_f32_16x16x32_bf16 v[52:55], v[72:75], v[132:135], v[52:55]
    v_mfma_f32_16x16x32_bf16 v[60:63], v[76:79], v[132:135], v[60:63]
    v_mfma_f32_16x16x32_bf16 v[68:71], v[80:83], v[132:135], v[68:71]
    buffer_load_dwordx4 v6, s[56:59], s90 offen offset:2048 lds
    s_cmp_eq_u32 s88, 10
    s_cselect_b32 s88, 0, s88
    s_waitcnt vmcnt(7) lgkmcnt(0)
    s_barrier
    v_lshrrev_b32 v16, 3, v1
    v_lshlrev_b32 v16, 12, v16
    v_and_b32 v17, 7, v1
    v_bfe_u32 v18, v1, 4, 1
    v_xor_b32 v17, v17, v18
    v_xor_b32 v18, 0, v17
    v_lshl_add_u32 v2, v18, 4, v16
    v_xor_b32 v18, 2, v17
    v_lshl_add_u32 v3, v18, 4, v16
    v_add_u32 v3, 31744, v3
    v_xor_b32 v18, 4, v17
    v_lshl_add_u32 v15, v18, 4, v16
    v_add_u32 v15, 63488, v15
    v_xor_b32 v18, 6, v17
    v_lshl_add_u32 v0, v18, 4, v16
    v_add_u32 v0, 95232, v0
    s_lshl_b32 s94, s82, 18
    s_mul_i32 s3, s81, 20480
    s_lshl_b32 s5, s83, 3
    s_add_u32 s5, s5, s82
    s_and_b32 s5, s5, 31
    s_add_u32 s5, s5, s81
    ds_read_b64_tr_b16 v[72:73], v11 offset:20480
    ds_read_b64_tr_b16 v[74:75], v11 offset:21248
    ds_read_b64_tr_b16 v[76:77], v11 offset:20512
    ds_read_b64_tr_b16 v[78:79], v11 offset:21280
    ds_read_b64_tr_b16 v[80:81], v11 offset:20544
    ds_read_b64_tr_b16 v[82:83], v11 offset:21312
    s_mul_i32 s90, s88, 196608
    s_add_u32 s90, s90, s95
    s_add_u32 m0, s4, 0
    s_add_u32 s88, s88, 1
    buffer_load_dwordx4 v4, s[56:59], s90 offen offset:0 lds
    v_mfma_f32_16x16x32_bf16 v[48:51], v[84:87], v[136:139], v[48:51]
    v_mfma_f32_16x16x32_bf16 v[56:59], v[88:91], v[136:139], v[56:59]
    v_mfma_f32_16x16x32_bf16 v[64:67], v[92:95], v[136:139], v[64:67]
    v_mfma_f32_16x16x32_bf16 v[52:55], v[84:87], v[140:143], v[52:55]
    v_mfma_f32_16x16x32_bf16 v[60:63], v[88:91], v[140:143], v[60:63]
    v_mfma_f32_16x16x32_bf16 v[68:71], v[92:95], v[140:143], v[68:71]
    buffer_load_dwordx4 v5, s[56:59], s90 offen offset:1024 lds
    ds_read_b64_tr_b16 v[84:85], v11 offset:26624
    ds_read_b64_tr_b16 v[86:87], v11 offset:27392
    ds_read_b64_tr_b16 v[88:89], v11 offset:26656
    ds_read_b64_tr_b16 v[90:91], v11 offset:27424
    ds_read_b64_tr_b16 v[92:93], v11 offset:26688
    ds_read_b64_tr_b16 v[94:95], v11 offset:27456
    s_waitcnt lgkmcnt(6)
    v_mfma_f32_16x16x32_bf16 v[48:51], v[72:75], v[144:147], v[48:51]
    v_mfma_f32_16x16x32_bf16 v[56:59], v[76:79], v[144:147], v[56:59]
    v_mfma_f32_16x16x32_bf16 v[64:67], v[80:83], v[144:147], v[64:67]
    v_mfma_f32_16x16x32_bf16 v[52:55], v[72:75], v[148:151], v[52:55]
    v_mfma_f32_16x16x32_bf16 v[60:63], v[76:79], v[148:151], v[60:63]
    v_mfma_f32_16x16x32_bf16 v[68:71], v[80:83], v[148:151], v[68:71]
    buffer_load_dwordx4 v6, s[56:59], s90 offen offset:2048 lds
    s_cmp_eq_u32 s88, 10
    s_cselect_b32 s88, 0, s88
    s_waitcnt vmcnt(6) lgkmcnt(0)
    s_barrier
    ds_read_b64_tr_b16 v[72:73], v12 offset:0
    ds_read_b64_tr_b16 v[74:75], v12 offset:768
    ds_read_b64_tr_b16 v[76:77], v12 offset:32
    ds_read_b64_tr_b16 v[78:79], v12 offset:800
    ds_read_b64_tr_b16 v[80:81], v12 offset:64
    ds_read_b64_tr_b16 v[82:83], v12 offset:832
    s_mul_i32 s90, s88, 196608
    s_add_u32 s90, s90, s95
    s_add_u32 m0, s4, 20480
    s_add_u32 s88, s88, 1
    buffer_load_dwordx4 v4, s[56:59], s90 offen offset:0 lds
    buffer_load_dwordx4 v5, s[56:59], s90 offen offset:1024 lds
    v_mfma_f32_16x16x32_bf16 v[48:51], v[84:87], v[152:155], v[48:51]
    v_mfma_f32_16x16x32_bf16 v[56:59], v[88:91], v[152:155], v[56:59]
    v_mfma_f32_16x16x32_bf16 v[64:67], v[92:95], v[152:155], v[64:67]
    v_mfma_f32_16x16x32_bf16 v[52:55], v[84:87], v[156:159], v[52:55]
    v_mfma_f32_16x16x32_bf16 v[60:63], v[88:91], v[156:159], v[60:63]
    v_mfma_f32_16x16x32_bf16 v[68:71], v[92:95], v[156:159], v[68:71]
    buffer_load_dwordx4 v6, s[56:59], s90 offen offset:2048 lds
    s_cmp_eq_u32 s88, 10
    s_cselect_b32 s88, 0, s88
    s_and_b32 s5, s5, 31
    s_lshl_b32 s77, s5, 7
    s_add_u32 s77, s77, s94
    s_add_u32 s5, s5, 4
    s_add_u32 m0, s3, 0
    s_nop 0
    buffer_load_dwordx4 v2, s[60:63], s77 offen offset:0 lds
    ds_read_b64_tr_b16 v[84:85], v12 offset:6144
    ds_read_b64_tr_b16 v[86:87], v12 offset:6912
    ds_read_b64_tr_b16 v[88:89], v12 offset:6176
    ds_read_b64_tr_b16 v[90:91], v12 offset:6944
    ds_read_b64_tr_b16 v[92:93], v12 offset:6208
    ds_read_b64_tr_b16 v[94:95], v12 offset:6976
    s_waitcnt lgkmcnt(6)
    s_add_u32 m0, s3, 0
    s_nop 0
    buffer_load_dwordx4 v3, s[60:63], s77 offen offset:1024 lds
    v_mfma_f32_16x16x32_bf16 v[48:51], v[72:75], v[160:163], v[48:51]
    v_mfma_f32_16x16x32_bf16 v[56:59], v[76:79], v[160:163], v[56:59]
    v_mfma_f32_16x16x32_bf16 v[64:67], v[80:83], v[160:163], v[64:67]
    v_mfma_f32_16x16x32_bf16 v[52:55], v[72:75], v[164:167], v[52:55]
    v_mfma_f32_16x16x32_bf16 v[60:63], v[76:79], v[164:167], v[60:63]
    v_mfma_f32_16x16x32_bf16 v[68:71], v[80:83], v[164:167], v[68:71]
    s_add_u32 m0, s3, 0
    s_nop 0
    buffer_load_dwordx4 v15, s[60:63], s77 offen offset:2048 lds
    s_add_u32 m0, s3, 0
    s_nop 0
    buffer_load_dwordx4 v0, s[60:63], s77 offen offset:3072 lds
    s_waitcnt vmcnt(10) lgkmcnt(0)
    s_barrier
    ds_read_b64_tr_b16 v[72:73], v12 offset:20480
    ds_read_b64_tr_b16 v[74:75], v12 offset:21248
    ds_read_b64_tr_b16 v[76:77], v12 offset:20512
    ds_read_b64_tr_b16 v[78:79], v12 offset:21280
    ds_read_b64_tr_b16 v[80:81], v12 offset:20544
    ds_read_b64_tr_b16 v[82:83], v12 offset:21312
    s_mul_i32 s90, s88, 196608
    s_add_u32 s90, s90, s95
    s_add_u32 m0, s4, 40960
    s_add_u32 s88, s88, 1
    buffer_load_dwordx4 v4, s[56:59], s90 offen offset:0 lds
    buffer_load_dwordx4 v5, s[56:59], s90 offen offset:1024 lds
    v_mfma_f32_16x16x32_bf16 v[48:51], v[84:87], v[168:171], v[48:51]
    v_mfma_f32_16x16x32_bf16 v[56:59], v[88:91], v[168:171], v[56:59]
    v_mfma_f32_16x16x32_bf16 v[64:67], v[92:95], v[168:171], v[64:67]
    v_mfma_f32_16x16x32_bf16 v[52:55], v[84:87], v[172:175], v[52:55]
    v_mfma_f32_16x16x32_bf16 v[60:63], v[88:91], v[172:175], v[60:63]
    v_mfma_f32_16x16x32_bf16 v[68:71], v[92:95], v[172:175], v[68:71]
    buffer_load_dwordx4 v6, s[56:59], s90 offen offset:2048 lds
    s_cmp_eq_u32 s88, 10
    s_cselect_b32 s88, 0, s88
    s_add_u32 s77, s77, 131072
    s_add_u32 m0, s3, 4096
    s_nop 0
    buffer_load_dwordx4 v2, s[60:63], s77 offen offset:0 lds
    v_lshlrev_b32 v13, 4, v1
    s_lshl_b32 s91, s82, 14
    s_lshl_b32 s92, s86, 13
    s_add_u32 s91, s91, s92
    s_add_u32 s91, s91, 65536
    v_add_u32 v13, s91, v13
    s_movk_i32 s92, 4096
    buffer_load_dwordx4 v[96:99], v13, s[68:71], 0 offen offset:0 sc1
    buffer_load_dwordx4 v[100:103], v13, s[68:71], 0 offen offset:1024 sc1
    buffer_load_dwordx4 v[104:107], v13, s[68:71], 0 offen offset:2048 sc1
    buffer_load_dwordx4 v[108:111], v13, s[68:71], 0 offen offset:3072 sc1
    buffer_load_dwordx4 v[112:115], v13, s[68:71], s92 offen offset:0 sc1
    buffer_load_dwordx4 v[116:119], v13, s[68:71], s92 offen offset:1024 sc1
    buffer_load_dwordx4 v[120:123], v13, s[68:71], s92 offen offset:2048 sc1
    buffer_load_dwordx4 v[124:127], v13, s[68:71], s92 offen offset:3072 sc1
    ds_read_b64_tr_b16 v[84:85], v12 offset:26624
    ds_read_b64_tr_b16 v[86:87], v12 offset:27392
    ds_read_b64_tr_b16 v[88:89], v12 offset:26656
    ds_read_b64_tr_b16 v[90:91], v12 offset:27424
    ds_read_b64_tr_b16 v[92:93], v12 offset:26688
    ds_read_b64_tr_b16 v[94:95], v12 offset:27456
    s_waitcnt lgkmcnt(6)
    s_add_u32 m0, s3, 4096
    s_nop 0
    buffer_load_dwordx4 v3, s[60:63], s77 offen offset:1024 lds
    v_mfma_f32_16x16x32_bf16 v[48:51], v[72:75], v[176:179], v[48:51]
    v_mfma_f32_16x16x32_bf16 v[56:59], v[76:79], v[176:179], v[56:59]
    v_mfma_f32_16x16x32_bf16 v[64:67], v[80:83], v[176:179], v[64:67]
    v_mfma_f32_16x16x32_bf16 v[52:55], v[72:75], v[180:183], v[52:55]
    v_mfma_f32_16x16x32_bf16 v[60:63], v[76:79], v[180:183], v[60:63]
    v_mfma_f32_16x16x32_bf16 v[68:71], v[80:83], v[180:183], v[68:71]
    s_add_u32 m0, s3, 4096
    s_nop 0
    buffer_load_dwordx4 v15, s[60:63], s77 offen offset:2048 lds
    s_add_u32 m0, s3, 4096
    s_nop 0
    buffer_load_dwordx4 v0, s[60:63], s77 offen offset:3072 lds
    s_waitcnt vmcnt(22) lgkmcnt(0)
    s_barrier
    ds_read_b64_tr_b16 v[72:73], v11 offset:0
    ds_read_b64_tr_b16 v[74:75], v11 offset:768
    ds_read_b64_tr_b16 v[76:77], v11 offset:32
    ds_read_b64_tr_b16 v[78:79], v11 offset:800
    ds_read_b64_tr_b16 v[80:81], v11 offset:64
    ds_read_b64_tr_b16 v[82:83], v11 offset:832
    s_mul_i32 s90, s88, 196608
    s_add_u32 s90, s90, s95
    s_add_u32 m0, s4, 61440
    s_add_u32 s88, s88, 1
    buffer_load_dwordx4 v4, s[56:59], s90 offen offset:0 lds
    v_mfma_f32_16x16x32_bf16 v[48:51], v[84:87], v[184:187], v[48:51]
    v_mfma_f32_16x16x32_bf16 v[56:59], v[88:91], v[184:187], v[56:59]
    v_mfma_f32_16x16x32_bf16 v[64:67], v[92:95], v[184:187], v[64:67]
    v_mfma_f32_16x16x32_bf16 v[52:55], v[84:87], v[188:191], v[52:55]
    v_mfma_f32_16x16x32_bf16 v[60:63], v[88:91], v[188:191], v[60:63]
    v_mfma_f32_16x16x32_bf16 v[68:71], v[92:95], v[188:191], v[68:71]
    buffer_load_dwordx4 v5, s[56:59], s90 offen offset:1024 lds
    buffer_load_dwordx4 v6, s[56:59], s90 offen offset:2048 lds
    s_cmp_eq_u32 s88, 10
    s_cselect_b32 s88, 0, s88
    s_mov_b32 s93, 100000
    s_waitcnt vmcnt(6)
L_ln_check:
    v_min_u32 v16, v97, v99
    v_max_u32 v17, v97, v99
    v_min3_u32 v16, v16, v101, v103
    v_max3_u32 v17, v17, v101, v103
    v_min3_u32 v16, v16, v105, v107
    v_max3_u32 v17, v17, v105, v107
    v_min3_u32 v16, v16, v109, v111
    v_max3_u32 v17, v17, v109, v111
    v_min3_u32 v16, v16, v113, v115
    v_max3_u32 v17, v17, v113, v115
    v_min3_u32 v16, v16, v117, v119
    v_max3_u32 v17, v17, v117, v119
    v_min3_u32 v16, v16, v121, v123
    v_max3_u32 v17, v17, v121, v123
    v_min3_u32 v16, v16, v125, v127
    v_max3_u32 v17, v17, v125, v127
    v_cmp_ne_u32 vcc, s80, v16
    v_cmp_ne_u32 s[84:85], s80, v17
    s_nop 3
    s_or_b64 vcc, vcc, s[84:85]
    s_cbranch_vccz L_ln_done
    s_movk_i32 s92, 4096
    buffer_load_dwordx4 v[96:99], v13, s[68:71], 0 offen offset:0 sc1
    buffer_load_dwordx4 v[100:103], v13, s[68:71], 0 offen offset:1024 sc1
    buffer_load_dwordx4 v[104:107], v13, s[68:71], 0 offen offset:2048 sc1
    buffer_load_dwordx4 v[108:111], v13, s[68:71], 0 offen offset:3072 sc1
    buffer_load_dwordx4 v[112:115], v13, s[68:71], s92 offen offset:0 sc1
    buffer_load_dwordx4 v[116:119], v13, s[68:71], s92 offen offset:1024 sc1
    buffer_load_dwordx4 v[120:123], v13, s[68:71], s92 offen offset:2048 sc1
    buffer_load_dwordx4 v[124:127], v13, s[68:71], s92 offen offset:3072 sc1
    s_waitcnt vmcnt(0)
    s_sub_u32 s93, s93, 1
    s_cmp_lg_u32 s93, 0
    s_cbranch_scc1 L_ln_check
L_ln_done:
    v_add_f32_dpp v96, v96, v96 row_ror:8 row_mask:0xf bank_mask:0x3
    v_add_f32_dpp v100, v100, v100 row_ror:8 row_mask:0xf bank_mask:0x3
    v_add_f32_dpp v104, v104, v104 row_ror:8 row_mask:0xf bank_mask:0x3
    v_add_f32_dpp v108, v108, v108 row_ror:8 row_mask:0xf bank_mask:0x3
    v_add_f32_dpp v112, v112, v112 row_ror:8 row_mask:0xf bank_mask:0x3
    v_add_f32_dpp v116, v116, v116 row_ror:8 row_mask:0xf bank_mask:0x3
    v_add_f32_dpp v120, v120, v120 row_ror:8 row_mask:0xf bank_mask:0x3
    v_add_f32_dpp v124, v124, v124 row_ror:8 row_mask:0xf bank_mask:0x3
    v_add_f32_dpp v96, v98, v98 row_ror:8 row_mask:0xf bank_mask:0xc
    v_add_f32_dpp v100, v102, v102 row_ror:8 row_mask:0xf bank_mask:0xc
    v_add_f32_dpp v104, v106, v106 row_ror:8 row_mask:0xf bank_mask:0xc
    v_add_f32_dpp v108, v110, v110 row_ror:8 row_mask:0xf bank_mask:0xc
    v_add_f32_dpp v112, v114, v114 row_ror:8 row_mask:0xf bank_mask:0xc
    v_add_f32_dpp v116, v118, v118 row_ror:8 row_mask:0xf bank_mask:0xc
    v_add_f32_dpp v120, v122, v122 row_ror:8 row_mask:0xf bank_mask:0xc
    v_add_f32_dpp v124, v126, v126 row_ror:8 row_mask:0xf bank_mask:0xc
    v_add_f32_dpp v96, v96, v96 row_half_mirror row_mask:0xf bank_mask:0x5
    v_add_f32_dpp v100, v100, v100 row_half_mirror row_mask:0xf bank_mask:0x5
    v_add_f32_dpp v104, v104, v104 row_half_mirror row_mask:0xf bank_mask:0x5
    v_add_f32_dpp v108, v108, v108 row_half_mirror row_mask:0xf bank_mask:0x5
    v_add_f32_dpp v96, v112, v112 row_half_mirror row_mask:0xf bank_mask:0xa
    v_add_f32_dpp v100, v116, v116 row_half_mirror row_mask:0xf bank_mask:0xa
    v_add_f32_dpp v104, v120, v120 row_half_mirror row_mask:0xf bank_mask:0xa
    v_add_f32_dpp v108, v124, v124 row_half_mirror row_mask:0xf bank_mask:0xa
    v_and_b32 v16, 15, v1
    v_lshrrev_b32 v17, 4, v1
    v_and_b32 v18, 3, v1
    v_add_f32_dpp v96, v96, v96 quad_perm:[3,2,1,0] row_mask:0xf bank_mask:0xf
    v_add_f32_dpp v100, v100, v100 quad_perm:[3,2,1,0] row_mask:0xf bank_mask:0xf
    v_add_f32_dpp v104, v104, v104 quad_perm:[3,2,1,0] row_mask:0xf bank_mask:0xf
    v_add_f32_dpp v108, v108, v108 quad_perm:[3,2,1,0] row_mask:0xf bank_mask:0xf
    v_add_f32_dpp v96, v96, v96 quad_perm:[1,0,3,2] row_mask:0xf bank_mask:0xf
    v_add_f32_dpp v100, v100, v100 quad_perm:[1,0,3,2] row_mask:0xf bank_mask:0xf
    v_add_f32_dpp v104, v104, v104 quad_perm:[1,0,3,2] row_mask:0xf bank_mask:0xf
    v_add_f32_dpp v108, v108, v108 quad_perm:[1,0,3,2] row_mask:0xf bank_mask:0xf
    v_cmp_eq_u32 vcc, 1, v18
    v_cmp_eq_u32 s[84:85], 2, v18
    v_cmp_eq_u32 s[12:13], 3, v18
    v_mul_u32_u24 v17, 96, v17
    v_cndmask_b32 v96, v96, v100, vcc
    v_cndmask_b32 v96, v96, v104, s[84:85]
    v_cndmask_b32 v96, v96, v108, s[12:13]
    s_nop 1
    v_mov_b32_dpp v97, v96 row_ror:8 row_mask:0xf bank_mask:0xf
    v_mul_f32 v96, 0x3aaaaaab, v96
    v_mul_f32 v97, 0x3aaaaaab, v97
    v_fma_f32 v97, -v96, v96, v97
    v_max_f32 v97, 0, v97
    v_cvt_pk_bf16_f32 v98, v96, v97
    v_lshlrev_b32 v96, 16, v98
    v_and_b32 v97, 0xffff0000, v98
    v_add_f32 v97, 0x3727c5ac, v97
    v_add_u32 v16, v16, v17
    v_cvt_pk_bf16_f32 v97, v97, v97
    v_and_b32 v97, 0xffff0000, v97
    v_sqrt_f32 v97, v97
    v_mov_b32_dpp v112, v96 row_newbcast:0 row_mask:0xf bank_mask:0xf
    v_mov_b32_dpp v113, v96 row_newbcast:1 row_mask:0xf bank_mask:0xf
    v_mov_b32_dpp v114, v96 row_newbcast:2 row_mask:0xf bank_mask:0xf
    v_mov_b32_dpp v115, v96 row_newbcast:3 row_mask:0xf bank_mask:0xf
    v_mov_b32_dpp v116, v96 row_newbcast:4 row_mask:0xf bank_mask:0xf
    v_mov_b32_dpp v117, v96 row_newbcast:5 row_mask:0xf bank_mask:0xf
    v_mov_b32_dpp v118, v96 row_newbcast:6 row_mask:0xf bank_mask:0xf
    v_mov_b32_dpp v119, v96 row_newbcast:7 row_mask:0xf bank_mask:0xf
    v_cvt_pk_bf16_f32 v97, v97, v97
    v_and_b32 v97, 0xffff0000, v97
    v_rcp_f32 v97, v97
    s_mul_i32 s91, s86, 384
    s_mul_i32 s92, s87, 48
    s_add_u32 s91, s91, s92
    v_add_u32 v16, s91, v16
    v_lshlrev_b32 v14, 4, v16
    v_mov_b32_dpp v120, v97 row_newbcast:0 row_mask:0xf bank_mask:0xf
    v_mov_b32_dpp v121, v97 row_newbcast:1 row_mask:0xf bank_mask:0xf
    v_mov_b32_dpp v122, v97 row_newbcast:2 row_mask:0xf bank_mask:0xf
    v_mov_b32_dpp v123, v97 row_newbcast:3 row_mask:0xf bank_mask:0xf
    v_mov_b32_dpp v124, v97 row_newbcast:4 row_mask:0xf bank_mask:0xf
    v_mov_b32_dpp v125, v97 row_newbcast:5 row_mask:0xf bank_mask:0xf
    v_mov_b32_dpp v126, v97 row_newbcast:6 row_mask:0xf bank_mask:0xf
    v_mov_b32_dpp v127, v97 row_newbcast:7 row_mask:0xf bank_mask:0xf
    s_lshl_b32 s91, s83, 5
    s_add_u32 s91, s91, s82
    s_lshl_b32 s11, s91, 2
    s_add_u32 s11, s11, 4096
    s_mul_i32 s91, s91, 12288
    s_add_u32 s91, s91, 1048576
    v_lshlrev_b32 v16, 16, v24
    v_lshlrev_b32 v20, 16, v26
    v_and_b32 v17, 0xffff0000, v24
    v_and_b32 v21, 0xffff0000, v26
    v_pk_add_f32 v[16:17], v[16:17], v[112:113] neg_lo:[0,1] neg_hi:[0,1]
    v_pk_add_f32 v[20:21], v[20:21], v[114:115] neg_lo:[0,1] neg_hi:[0,1]
    v_cvt_pk_bf16_f32 v18, v16, v17
    v_cvt_pk_bf16_f32 v22, v20, v21
    v_lshlrev_b32 v16, 16, v18
    v_lshlrev_b32 v20, 16, v22
    v_and_b32 v17, 0xffff0000, v18
    v_and_b32 v21, 0xffff0000, v22
    v_pk_mul_f32 v[16:17], v[16:17], v[120:121]
    v_pk_mul_f32 v[20:21], v[20:21], v[122:123]
    v_cvt_pk_bf16_f32 v128, v16, v17
    v_cvt_pk_bf16_f32 v129, v20, v21
    v_lshlrev_b32 v16, 16, v36
    v_lshlrev_b32 v20, 16, v38
    v_and_b32 v17, 0xffff0000, v36
    v_and_b32 v21, 0xffff0000, v38
    v_pk_add_f32 v[16:17], v[16:17], v[116:117] neg_lo:[0,1] neg_hi:[0,1]
    v_pk_add_f32 v[20:21], v[20:21], v[118:119] neg_lo:[0,1] neg_hi:[0,1]
    v_cvt_pk_bf16_f32 v18, v16, v17
    v_cvt_pk_bf16_f32 v22, v20, v21
    v_lshlrev_b32 v16, 16, v18
    v_lshlrev_b32 v20, 16, v22
    v_and_b32 v17, 0xffff0000, v18
    v_and_b32 v21, 0xffff0000, v22
    v_pk_mul_f32 v[16:17], v[16:17], v[124:125]
    v_pk_mul_f32 v[20:21], v[20:21], v[126:127]
    v_cvt_pk_bf16_f32 v130, v16, v17
    v_cvt_pk_bf16_f32 v131, v20, v21
    buffer_store_dwordx4 v[128:131], v14, s[68:71], s91 offen offset:0 sc1
    v_lshlrev_b32 v16, 16, v28
    v_lshlrev_b32 v20, 16, v30
    v_and_b32 v17, 0xffff0000, v28
    v_and_b32 v21, 0xffff0000, v30
    v_pk_add_f32 v[16:17], v[16:17], v[112:113] neg_lo:[0,1] neg_hi:[0,1]
    v_pk_add_f32 v[20:21], v[20:21], v[114:115] neg_lo:[0,1] neg_hi:[0,1]
    v_cvt_pk_bf16_f32 v18, v16, v17
    v_cvt_pk_bf16_f32 v22, v20, v21
    v_lshlrev_b32 v16, 16, v18
    v_lshlrev_b32 v20, 16, v22
    v_and_b32 v17, 0xffff0000, v18
    v_and_b32 v21, 0xffff0000, v22
    v_pk_mul_f32 v[16:17], v[16:17], v[120:121]
    v_pk_mul_f32 v[20:21], v[20:21], v[122:123]
    v_cvt_pk_bf16_f32 v132, v16, v17
    v_cvt_pk_bf16_f32 v133, v20, v21
    v_lshlrev_b32 v16, 16, v40
    v_lshlrev_b32 v20, 16, v42
    v_and_b32 v17, 0xffff0000, v40
    v_and_b32 v21, 0xffff0000, v42
    v_pk_add_f32 v[16:17], v[16:17], v[116:117] neg_lo:[0,1] neg_hi:[0,1]
    v_pk_add_f32 v[20:21], v[20:21], v[118:119] neg_lo:[0,1] neg_hi:[0,1]
    v_cvt_pk_bf16_f32 v18, v16, v17
    v_cvt_pk_bf16_f32 v22, v20, v21
    v_lshlrev_b32 v16, 16, v18
    v_lshlrev_b32 v20, 16, v22
    v_and_b32 v17, 0xffff0000, v18
    v_and_b32 v21, 0xffff0000, v22
    v_pk_mul_f32 v[16:17], v[16:17], v[124:125]
    v_pk_mul_f32 v[20:21], v[20:21], v[126:127]
    v_cvt_pk_bf16_f32 v134, v16, v17
    v_cvt_pk_bf16_f32 v135, v20, v21
    buffer_store_dwordx4 v[132:135], v14, s[68:71], s91 offen offset:256 sc1
    v_lshlrev_b32 v16, 16, v32
    v_lshlrev_b32 v20, 16, v34
    v_and_b32 v17, 0xffff0000, v32
    v_and_b32 v21, 0xffff0000, v34
    v_pk_add_f32 v[16:17], v[16:17], v[112:113] neg_lo:[0,1] neg_hi:[0,1]
    v_pk_add_f32 v[20:21], v[20:21], v[114:115] neg_lo:[0,1] neg_hi:[0,1]
    v_cvt_pk_bf16_f32 v18, v16, v17
    v_cvt_pk_bf16_f32 v22, v20, v21
    v_lshlrev_b32 v16, 16, v18
    v_lshlrev_b32 v20, 16, v22
    v_and_b32 v17, 0xffff0000, v18
    v_and_b32 v21, 0xffff0000, v22
    v_pk_mul_f32 v[16:17], v[16:17], v[120:121]
    v_pk_mul_f32 v[20:21], v[20:21], v[122:123]
    v_cvt_pk_bf16_f32 v136, v16, v17
    v_cvt_pk_bf16_f32 v137, v20, v21
    v_lshlrev_b32 v16, 16, v44
    v_lshlrev_b32 v20, 16, v46
    v_and_b32 v17, 0xffff0000, v44
    v_and_b32 v21, 0xffff0000, v46
    v_pk_add_f32 v[16:17], v[16:17], v[116:117] neg_lo:[0,1] neg_hi:[0,1]
    v_pk_add_f32 v[20:21], v[20:21], v[118:119] neg_lo:[0,1] neg_hi:[0,1]
    v_cvt_pk_bf16_f32 v18, v16, v17
    v_cvt_pk_bf16_f32 v22, v20, v21
    v_lshlrev_b32 v16, 16, v18
    v_lshlrev_b32 v20, 16, v22
    v_and_b32 v17, 0xffff0000, v18
    v_and_b32 v21, 0xffff0000, v22
    v_pk_mul_f32 v[16:17], v[16:17], v[124:125]
    v_pk_mul_f32 v[20:21], v[20:21], v[126:127]
    v_cvt_pk_bf16_f32 v138, v16, v17
    v_cvt_pk_bf16_f32 v139, v20, v21
    buffer_store_dwordx4 v[136:139], v14, s[68:71], s91 offen offset:512 sc1
    ds_read_b64_tr_b16 v[84:85], v11 offset:6144
    ds_read_b64_tr_b16 v[86:87], v11 offset:6912
    ds_read_b64_tr_b16 v[88:89], v11 offset:6176
    ds_read_b64_tr_b16 v[90:91], v11 offset:6944
    ds_read_b64_tr_b16 v[92:93], v11 offset:6208
    ds_read_b64_tr_b16 v[94:95], v11 offset:6976
    s_waitcnt lgkmcnt(6)
    v_mfma_f32_16x16x32_bf16 v[48:51], v[72:75], v[192:195], v[48:51]
    v_mfma_f32_16x16x32_bf16 v[56:59], v[76:79], v[192:195], v[56:59]
    v_mfma_f32_16x16x32_bf16 v[64:67], v[80:83], v[192:195], v[64:67]
    v_mfma_f32_16x16x32_bf16 v[52:55], v[72:75], v[196:199], v[52:55]
    v_mfma_f32_16x16x32_bf16 v[60:63], v[76:79], v[196:199], v[60:63]
    v_mfma_f32_16x16x32_bf16 v[68:71], v[80:83], v[196:199], v[68:71]
    s_waitcnt vmcnt(25) lgkmcnt(0)
    s_barrier
    ds_read_b64_tr_b16 v[72:73], v11 offset:20480
    ds_read_b64_tr_b16 v[74:75], v11 offset:21248
    ds_read_b64_tr_b16 v[76:77], v11 offset:20512
    ds_read_b64_tr_b16 v[78:79], v11 offset:21280
    ds_read_b64_tr_b16 v[80:81], v11 offset:20544
    ds_read_b64_tr_b16 v[82:83], v11 offset:21312
    v_mfma_f32_16x16x32_bf16 v[48:51], v[84:87], v[200:203], v[48:51]
    v_mfma_f32_16x16x32_bf16 v[56:59], v[88:91], v[200:203], v[56:59]
    v_mfma_f32_16x16x32_bf16 v[64:67], v[92:95], v[200:203], v[64:67]
    v_mfma_f32_16x16x32_bf16 v[52:55], v[84:87], v[204:207], v[52:55]
    v_mfma_f32_16x16x32_bf16 v[60:63], v[88:91], v[204:207], v[60:63]
    v_mfma_f32_16x16x32_bf16 v[68:71], v[92:95], v[204:207], v[68:71]
    ds_read_b64_tr_b16 v[84:85], v11 offset:26624
    ds_read_b64_tr_b16 v[86:87], v11 offset:27392
    ds_read_b64_tr_b16 v[88:89], v11 offset:26656
    ds_read_b64_tr_b16 v[90:91], v11 offset:27424
    ds_read_b64_tr_b16 v[92:93], v11 offset:26688
    ds_read_b64_tr_b16 v[94:95], v11 offset:27456
    s_waitcnt lgkmcnt(6)
    v_mfma_f32_16x16x32_bf16 v[48:51], v[72:75], v[208:211], v[48:51]
    v_mfma_f32_16x16x32_bf16 v[56:59], v[76:79], v[208:211], v[56:59]
    v_mfma_f32_16x16x32_bf16 v[64:67], v[80:83], v[208:211], v[64:67]
    v_mfma_f32_16x16x32_bf16 v[52:55], v[72:75], v[212:215], v[52:55]
    v_mfma_f32_16x16x32_bf16 v[60:63], v[76:79], v[212:215], v[60:63]
    v_mfma_f32_16x16x32_bf16 v[68:71], v[80:83], v[212:215], v[68:71]
    s_waitcnt vmcnt(0) lgkmcnt(0)
    s_barrier
    s_cmp_lg_u32 s81, 0
    s_cbranch_scc1 L_fz_skip
    v_mov_b32 v16, s80
    s_mov_b64 s[12:13], exec
    s_mov_b64 exec, 1
    buffer_store_dword v16, off, s[68:71], s11 sc1
    s_mov_b64 exec, s[12:13]
L_fz_skip:
    ds_read_b64_tr_b16 v[72:73], v12 offset:0
    ds_read_b64_tr_b16 v[74:75], v12 offset:768
    ds_read_b64_tr_b16 v[76:77], v12 offset:32
    ds_read_b64_tr_b16 v[78:79], v12 offset:800
    ds_read_b64_tr_b16 v[80:81], v12 offset:64
    ds_read_b64_tr_b16 v[82:83], v12 offset:832
    v_mfma_f32_16x16x32_bf16 v[48:51], v[84:87], v[216:219], v[48:51]
    v_mfma_f32_16x16x32_bf16 v[56:59], v[88:91], v[216:219], v[56:59]
    v_mfma_f32_16x16x32_bf16 v[64:67], v[92:95], v[216:219], v[64:67]
    v_mfma_f32_16x16x32_bf16 v[52:55], v[84:87], v[220:223], v[52:55]
    v_mfma_f32_16x16x32_bf16 v[60:63], v[88:91], v[220:223], v[60:63]
    v_mfma_f32_16x16x32_bf16 v[68:71], v[92:95], v[220:223], v[68:71]
    ds_read_b64_tr_b16 v[84:85], v12 offset:6144
    ds_read_b64_tr_b16 v[86:87], v12 offset:6912
    ds_read_b64_tr_b16 v[88:89], v12 offset:6176
    ds_read_b64_tr_b16 v[90:91], v12 offset:6944
    ds_read_b64_tr_b16 v[92:93], v12 offset:6208
    ds_read_b64_tr_b16 v[94:95], v12 offset:6976
    s_waitcnt lgkmcnt(6)
    v_mfma_f32_16x16x32_bf16 v[48:51], v[72:75], v[224:227], v[48:51]
    v_mfma_f32_16x16x32_bf16 v[56:59], v[76:79], v[224:227], v[56:59]
    v_mfma_f32_16x16x32_bf16 v[64:67], v[80:83], v[224:227], v[64:67]
    v_mfma_f32_16x16x32_bf16 v[52:55], v[72:75], v[228:231], v[52:55]
    v_mfma_f32_16x16x32_bf16 v[60:63], v[76:79], v[228:231], v[60:63]
    v_mfma_f32_16x16x32_bf16 v[68:71], v[80:83], v[228:231], v[68:71]
    s_waitcnt vmcnt(3) lgkmcnt(0)
    s_barrier
    ds_read_b64_tr_b16 v[72:73], v12 offset:20480
    ds_read_b64_tr_b16 v[74:75], v12 offset:21248
    ds_read_b64_tr_b16 v[76:77], v12 offset:20512
    ds_read_b64_tr_b16 v[78:79], v12 offset:21280
    ds_read_b64_tr_b16 v[80:81], v12 offset:20544
    ds_read_b64_tr_b16 v[82:83], v12 offset:21312
    v_mfma_f32_16x16x32_bf16 v[48:51], v[84:87], v[232:235], v[48:51]
    v_mfma_f32_16x16x32_bf16 v[56:59], v[88:91], v[232:235], v[56:59]
    v_mfma_f32_16x16x32_bf16 v[64:67], v[92:95], v[232:235], v[64:67]
    v_mfma_f32_16x16x32_bf16 v[52:55], v[84:87], v[236:239], v[52:55]
    v_mfma_f32_16x16x32_bf16 v[60:63], v[88:91], v[236:239], v[60:63]
    v_mfma_f32_16x16x32_bf16 v[68:71], v[92:95], v[236:239], v[68:71]
    ds_read_b64_tr_b16 v[84:85], v12 offset:26624
    ds_read_b64_tr_b16 v[86:87], v12 offset:27392
    ds_read_b64_tr_b16 v[88:89], v12 offset:26656
    ds_read_b64_tr_b16 v[90:91], v12 offset:27424
    ds_read_b64_tr_b16 v[92:93], v12 offset:26688
    ds_read_b64_tr_b16 v[94:95], v12 offset:27456
    s_waitcnt lgkmcnt(6)
    v_mfma_f32_16x16x32_bf16 v[48:51], v[72:75], v[240:243], v[48:51]
    v_mfma_f32_16x16x32_bf16 v[56:59], v[76:79], v[240:243], v[56:59]
    v_mfma_f32_16x16x32_bf16 v[64:67], v[80:83], v[240:243], v[64:67]
    v_mfma_f32_16x16x32_bf16 v[52:55], v[72:75], v[244:247], v[52:55]
    v_mfma_f32_16x16x32_bf16 v[60:63], v[76:79], v[244:247], v[60:63]
    v_mfma_f32_16x16x32_bf16 v[68:71], v[80:83], v[244:247], v[68:71]
    s_waitcnt lgkmcnt(0)
    s_barrier
    v_mfma_f32_16x16x32_bf16 v[48:51], v[84:87], v[248:251], v[48:51]
    v_mfma_f32_16x16x32_bf16 v[56:59], v[88:91], v[248:251], v[56:59]
    v_mfma_f32_16x16x32_bf16 v[64:67], v[92:95], v[248:251], v[64:67]
    v_mfma_f32_16x16x32_bf16 v[52:55], v[84:87], v[252:255], v[52:55]
    v_mfma_f32_16x16x32_bf16 v[60:63], v[88:91], v[252:255], v[60:63]
    v_mfma_f32_16x16x32_bf16 v[68:71], v[92:95], v[252:255], v[68:71]
    s_and_b32 s5, s5, 31
    s_lshl_b32 s77, s5, 7
    s_add_u32 s77, s77, s94
    s_add_u32 s5, s5, 4
    s_add_u32 m0, s3, 8192
    s_nop 0
    buffer_load_dwordx4 v2, s[60:63], s77 offen offset:0 lds
    s_add_u32 m0, s3, 8192
    s_nop 0
    buffer_load_dwordx4 v3, s[60:63], s77 offen offset:1024 lds
    s_add_u32 m0, s3, 8192
    s_nop 0
    buffer_load_dwordx4 v15, s[60:63], s77 offen offset:2048 lds
    s_add_u32 m0, s3, 8192
    s_nop 0
    buffer_load_dwordx4 v0, s[60:63], s77 offen offset:3072 lds
    s_add_u32 s77, s77, 131072
    s_add_u32 m0, s3, 12288
    s_nop 0
    buffer_load_dwordx4 v2, s[60:63], s77 offen offset:0 lds
    s_add_u32 m0, s3, 12288
    s_nop 0
    buffer_load_dwordx4 v3, s[60:63], s77 offen offset:1024 lds
    s_add_u32 m0, s3, 12288
    s_nop 0
    buffer_load_dwordx4 v15, s[60:63], s77 offen offset:2048 lds
    s_add_u32 m0, s3, 12288
    s_nop 0
    buffer_load_dwordx4 v0, s[60:63], s77 offen offset:3072 lds
    s_lshl_b32 s78, s83, 3
    s_add_u32 s78, s78, s82
    s_and_b32 s78, s78, 31
    s_add_u32 s91, s78, s81
    v_lshl_add_u32 v141, v1, 2, s91
    v_and_b32 v141, 31, v141
    v_lshlrev_b32 v141, 2, v141
    s_lshl_b32 s91, s83, 7
    s_add_u32 s91, s91, 4096
    v_add_u32 v141, s91, v141
    v_subrev_u32 v16, 8, v1
    v_min_u32 v16, 5, v16
    s_mul_i32 s91, s83, 24
    s_mul_i32 s92, s81, 6
    s_add_u32 s91, s91, s92
    v_add_u32 v16, s91, v16
    v_lshlrev_b32 v16, 2, v16
    v_add_u32 v16, 24576, v16
    v_cmp_gt_u32 vcc, 8, v1
    s_nop 1
    v_cndmask_b32 v141, v16, v141, vcc
    s_mov_b64 s[84:85], 0
    v_mov_b32 v142, 0xc0135761
    v_mov_b32 v143, 0xc0135761
    v_and_b32 v16, 15, v1
    v_lshrrev_b32 v17, 4, v1
    v_lshrrev_b32 v18, 2, v16
    v_lshlrev_b32 v18, 3, v18
    v_and_b32 v19, 3, v16
    v_add_u32 v18, v18, v19
    v_lshlrev_b32 v18, 3, v18
    v_mul_u32_u24 v19, 20480, v17
    v_add_u32 v18, v18, v19
    s_mul_i32 s91, s87, 1536
    s_lshl_b32 s92, s86, 8
    s_add_u32 s91, s91, s92
    s_add_u32 s91, s91, 16384
    v_add_u32 v14, s91, v18
    v_mov_b32 v18, 19456
    v_mov_b32 v19, 8
    ds_write_b32 v18, v19
    v_cvt_pk_bf16_f32 v128, v48, v49
    v_cvt_pk_bf16_f32 v129, v50, v51
    ds_write_b64 v14, v[128:129] offset:0
    v_cvt_pk_bf16_f32 v130, v52, v53
    v_cvt_pk_bf16_f32 v131, v54, v55
    ds_write_b64 v14, v[130:131] offset:32
    v_cvt_pk_bf16_f32 v132, v56, v57
    v_cvt_pk_bf16_f32 v133, v58, v59
    ds_write_b64 v14, v[132:133] offset:512
    v_cvt_pk_bf16_f32 v134, v60, v61
    v_cvt_pk_bf16_f32 v135, v62, v63
    ds_write_b64 v14, v[134:135] offset:544
    v_cvt_pk_bf16_f32 v136, v64, v65
    v_cvt_pk_bf16_f32 v137, v66, v67
    ds_write_b64 v14, v[136:137] offset:1024
    v_cvt_pk_bf16_f32 v138, v68, v69
    v_cvt_pk_bf16_f32 v139, v70, v71
    ds_write_b64 v14, v[138:139] offset:1056
    v_and_b32 v16, 31, v1
    v_lshrrev_b32 v17, 5, v1
    s_lshl_b32 s91, s81, 3
    v_add_u32 v19, s91, v16
    v_and_b32 v19, 31, v19
    v_mul_u32_u24 v18, 96, v17
    v_add_u32 v18, v18, v19
    v_lshlrev_b32 v4, 4, v18
    v_lshrrev_b32 v18, 3, v16
    v_lshlrev_b32 v18, 1, v18
    v_bfe_u32 v19, v16, 1, 1
    v_or_b32 v18, v18, v19
    v_xor_b32 v18, v18, v17
    v_lshlrev_b32 v19, 7, v16
    v_lshl_add_u32 v18, v18, 4, v19
    v_add_u32 v7, s3, v18
    v_xor_b32 v19, 32, v18
    v_add_u32 v8, s3, v19
    v_xor_b32 v19, 64, v18
    v_add_u32 v9, s3, v19
    v_xor_b32 v19, 96, v18
    v_add_u32 v10, s3, v19
    s_lshl_b32 s91, s87, 1
    v_add_u32 v18, s91, v17
    v_mul_u32_u24 v18, 20480, v18
    v_lshl_add_u32 v18, v16, 3, v18
    s_lshl_b32 s91, s86, 9
    s_add_u32 s91, s91, 16384
    v_add_u32 v11, s91, v18
    s_lshl_b32 s91, s82, 7
    v_lshlrev_b32 v18, 1, v16
    v_add_u32 v18, s91, v18
    global_load_ushort v252, v18, s[40:41]
    global_load_ushort v254, v18, s[40:41] offset:64
    s_lshl_b32 s10, s83, 3
    s_add_u32 s10, s10, s82
    s_and_b32 s10, s10, 31
    s_add_u32 s10, s10, s81
    s_mul_i32 s95, s83, 393216
    s_add_u32 s95, s95, 1048576
    s_waitcnt lgkmcnt(0)
    s_barrier
    s_bitcmp1_b32 s84, 0
    s_cbranch_scc1 L_nb0_ok
    s_mov_b32 s93, 100000
L_nb0_spin:
    buffer_load_dword v140, v141, s[68:71], 0 offen sc1
    s_waitcnt vmcnt(0)
    v_cmp_eq_u32 s[84:85], s80, v140
    s_nop 3
    s_bitcmp1_b32 s84, 0
    s_cbranch_scc1 L_nb0_ok
    s_sleep 4
    s_sub_u32 s93, s93, 1
    s_cmp_lg_u32 s93, 0
    s_cbranch_scc1 L_nb0_spin
L_nb0_ok:
    s_and_b32 s10, s10, 31
    s_mul_i32 s90, s10, 12288
    s_add_u32 s90, s90, s95
    s_add_u32 s10, s10, 4
    buffer_load_dwordx4 v[144:147], v4, s[68:71], s90 offen offset:0 sc1
    buffer_load_dwordx4 v[148:151], v4, s[68:71], s90 offen offset:512 sc1
    buffer_load_dwordx4 v[152:155], v4, s[68:71], s90 offen offset:1024 sc1
    s_add_u32 s90, s90, 3072
    buffer_load_dwordx4 v[156:159], v4, s[68:71], s90 offen offset:0 sc1
    buffer_load_dwordx4 v[160:163], v4, s[68:71], s90 offen offset:512 sc1
    buffer_load_dwordx4 v[164:167], v4, s[68:71], s90 offen offset:1024 sc1
    s_add_u32 s90, s90, 3072
    buffer_load_dwordx4 v[168:171], v4, s[68:71], s90 offen offset:0 sc1
    buffer_load_dwordx4 v[172:175], v4, s[68:71], s90 offen offset:512 sc1
    buffer_load_dwordx4 v[176:179], v4, s[68:71], s90 offen offset:1024 sc1
    s_add_u32 s90, s90, 3072
    buffer_load_dwordx4 v[180:183], v4, s[68:71], s90 offen offset:0 sc1
    buffer_load_dwordx4 v[184:187], v4, s[68:71], s90 offen offset:512 sc1
    buffer_load_dwordx4 v[188:191], v4, s[68:71], s90 offen offset:1024 sc1
    s_bitcmp1_b32 s84, 1
    s_cbranch_scc1 L_nb1_ok
    s_mov_b32 s93, 100000
L_nb1_spin:
    buffer_load_dword v140, v141, s[68:71], 0 offen sc1
    s_waitcnt vmcnt(0)
    v_cmp_eq_u32 s[84:85], s80, v140
    s_nop 3
    s_bitcmp1_b32 s84, 1
    s_cbranch_scc1 L_nb1_ok
    s_sleep 4
    s_sub_u32 s93, s93, 1
    s_cmp_lg_u32 s93, 0
    s_cbranch_scc1 L_nb1_spin
L_nb1_ok:
    s_and_b32 s10, s10, 31
    s_mul_i32 s90, s10, 12288
    s_add_u32 s90, s90, s95
    s_add_u32 s10, s10, 4
    buffer_load_dwordx4 v[192:195], v4, s[68:71], s90 offen offset:0 sc1
    buffer_load_dwordx4 v[196:199], v4, s[68:71], s90 offen offset:512 sc1
    buffer_load_dwordx4 v[200:203], v4, s[68:71], s90 offen offset:1024 sc1
    s_add_u32 s90, s90, 3072
    buffer_load_dwordx4 v[204:207], v4, s[68:71], s90 offen offset:0 sc1
    buffer_load_dwordx4 v[208:211], v4, s[68:71], s90 offen offset:512 sc1
    buffer_load_dwordx4 v[212:215], v4, s[68:71], s90 offen offset:1024 sc1
    s_add_u32 s90, s90, 3072
    buffer_load_dwordx4 v[216:219], v4, s[68:71], s90 offen offset:0 sc1
    buffer_load_dwordx4 v[220:223], v4, s[68:71], s90 offen offset:512 sc1
    buffer_load_dwordx4 v[224:227], v4, s[68:71], s90 offen offset:1024 sc1
    s_add_u32 s90, s90, 3072
    buffer_load_dwordx4 v[228:231], v4, s[68:71], s90 offen offset:0 sc1
    buffer_load_dwordx4 v[232:235], v4, s[68:71], s90 offen offset:512 sc1
    buffer_load_dwordx4 v[236:239], v4, s[68:71], s90 offen offset:1024 sc1
    buffer_load_dword v140, v141, s[68:71], 0 offen sc1
    ds_read_b64 v[240:241], v11 offset:0
    ds_read_b64 v[242:243], v11 offset:256
    ds_read_b64 v[244:245], v11 offset:1024
    ds_read_b64 v[246:247], v11 offset:1280
    ds_read_b64 v[248:249], v11 offset:2048
    ds_read_b64 v[250:251], v11 offset:2304
    v_lshlrev_b32 v5, 4, v1
    s_mul_i32 s76, s83, 122880
    s_mul_i32 s91, s81, 30720
    s_add_u32 s76, s76, s91
    s_add_u32 s76, s76, 13631488
    v_add_u32 v6, s3, v5
    s_sub_u32 s91, s81, 1
    s_and_b32 s91, s91, 3
    s_mul_i32 s91, s91, 20480
    s_add_u32 s91, s91, 0
    v_add_u32 v12, s91, v5
    s_sub_u32 s91, s81, 2
    s_and_b32 s91, s91, 3
    s_mul_i32 s91, s91, 20480
    s_add_u32 s91, s91, 6144
    v_add_u32 v13, s91, v5
    s_sub_u32 s91, s81, 3
    s_and_b32 s91, s91, 3
    s_mul_i32 s91, s91, 20480
    s_add_u32 s91, s91, 12288
    v_add_u32 v14, s91, v5
    s_waitcnt lgkmcnt(0)
    ds_read_b128 v[120:123], v7 offset:0
    ds_read_b128 v[124:127], v7 offset:4096
    v_cmp_eq_u32 s[84:85], s80, v140
    s_nop 3
    s_bitcmp1_b32 s84, 2
    s_cbranch_scc1 L_nb2_ok
    s_mov_b32 s93, 100000
L_nb2_spin:
    buffer_load_dword v140, v141, s[68:71], 0 offen sc1
    s_waitcnt vmcnt(0)
    v_cmp_eq_u32 s[84:85], s80, v140
    s_nop 3
    s_bitcmp1_b32 s84, 2
    s_cbranch_scc1 L_nb2_ok
    s_sleep 4
    s_sub_u32 s93, s93, 1
    s_cmp_lg_u32 s93, 0
    s_cbranch_scc1 L_nb2_spin
L_nb2_ok:
    buffer_load_dword v140, v141, s[68:71], 0 offen sc1
    s_waitcnt vmcnt(23) lgkmcnt(0)
    ds_read_b128 v[128:131], v8 offset:0
    ds_read_b128 v[132:135], v8 offset:4096
    v_mfma_f32_32x32x16_bf16 v[24:39], v[144:147], v[120:123], 0
    v_lshlrev_b32 v16, 16, v240
    v_lshlrev_b32 v20, 16, v241
    v_and_b32 v17, 0xffff0000, v240
    v_and_b32 v21, 0xffff0000, v241
    v_pk_mul_f32 v[18:19], v[16:17], v[16:17]
    v_pk_mul_f32 v[22:23], v[20:21], v[20:21]
    v_mfma_f32_32x32x16_bf16 v[56:71], v[148:151], v[120:123], 0
    v_pk_fma_f32 v[18:19], v[18:19], s[6:7], v[142:143]
    v_pk_fma_f32 v[22:23], v[22:23], s[6:7], v[142:143]
    v_pk_mul_f32 v[18:19], v[18:19], v[16:17]
    v_pk_mul_f32 v[22:23], v[22:23], v[20:21]
    v_exp_f32 v18, v18
    v_exp_f32 v22, v22
    v_mfma_f32_32x32x16_bf16 v[88:103], v[152:155], v[120:123], 0
    v_exp_f32 v19, v19
    v_exp_f32 v23, v23
    s_nop 0
    v_pk_add_f32 v[18:19], v[18:19], s[8:9]
    v_pk_add_f32 v[22:23], v[22:23], s[8:9]
    v_rcp_f32 v18, v18
    v_rcp_f32 v22, v22
    v_mfma_f32_32x32x16_bf16 v[40:55], v[144:147], v[124:127], 0
    s_and_b32 s10, s10, 31
    s_mul_i32 s90, s10, 12288
    s_add_u32 s90, s90, s95
    s_add_u32 s10, s10, 4
    buffer_load_dwordx4 v[144:147], v4, s[68:71], s90 offen offset:0 sc1
    v_rcp_f32 v19, v19
    v_rcp_f32 v23, v23
    s_nop 0
    v_pk_mul_f32 v[18:19], v[18:19], v[16:17]
    v_pk_mul_f32 v[22:23], v[22:23], v[20:21]
    v_cvt_pk_bf16_f32 v240, v18, v19
    v_cvt_pk_bf16_f32 v241, v22, v23
    v_mfma_f32_32x32x16_bf16 v[72:87], v[148:151], v[124:127], 0
    buffer_load_dwordx4 v[148:151], v4, s[68:71], s90 offen offset:512 sc1
    v_lshlrev_b32 v16, 16, v242
    v_lshlrev_b32 v20, 16, v243
    v_and_b32 v17, 0xffff0000, v242
    v_and_b32 v21, 0xffff0000, v243
    v_pk_mul_f32 v[18:19], v[16:17], v[16:17]
    v_pk_mul_f32 v[22:23], v[20:21], v[20:21]
    v_mfma_f32_32x32x16_bf16 v[104:119], v[152:155], v[124:127], 0
    buffer_load_dwordx4 v[152:155], v4, s[68:71], s90 offen offset:1024 sc1
    v_pk_fma_f32 v[18:19], v[18:19], s[6:7], v[142:143]
    v_pk_fma_f32 v[22:23], v[22:23], s[6:7], v[142:143]
    v_pk_mul_f32 v[18:19], v[18:19], v[16:17]
    v_pk_mul_f32 v[22:23], v[22:23], v[20:21]
    v_exp_f32 v18, v18
    v_exp_f32 v22, v22
    s_waitcnt vmcnt(23) lgkmcnt(0)
    ds_read_b128 v[120:123], v9 offset:0
    ds_read_b128 v[124:127], v9 offset:4096
    v_mfma_f32_32x32x16_bf16 v[24:39], v[156:159], v[128:131], v[24:39]
    v_exp_f32 v19, v19
    v_exp_f32 v23, v23
    s_nop 0
    v_pk_add_f32 v[18:19], v[18:19], s[8:9]
    v_pk_add_f32 v[22:23], v[22:23], s[8:9]
    v_rcp_f32 v18, v18
    v_rcp_f32 v22, v22
    v_mfma_f32_32x32x16_bf16 v[56:71], v[160:163], v[128:131], v[56:71]
    v_rcp_f32 v19, v19
    v_rcp_f32 v23, v23
    s_nop 0
    v_pk_mul_f32 v[18:19], v[18:19], v[16:17]
    v_pk_mul_f32 v[22:23], v[22:23], v[20:21]
    v_cvt_pk_bf16_f32 v242, v18, v19
    v_cvt_pk_bf16_f32 v243, v22, v23
    v_mfma_f32_32x32x16_bf16 v[88:103], v[164:167], v[128:131], v[88:103]
    v_lshlrev_b32 v16, 16, v244
    v_lshlrev_b32 v20, 16, v245
    v_and_b32 v17, 0xffff0000, v244
    v_and_b32 v21, 0xffff0000, v245
    v_pk_mul_f32 v[18:19], v[16:17], v[16:17]
    v_pk_mul_f32 v[22:23], v[20:21], v[20:21]
    v_mfma_f32_32x32x16_bf16 v[40:55], v[156:159], v[132:135], v[40:55]
    s_add_u32 s90, s90, 3072
    buffer_load_dwordx4 v[156:159], v4, s[68:71], s90 offen offset:0 sc1
    v_pk_fma_f32 v[18:19], v[18:19], s[6:7], v[142:143]
    v_pk_fma_f32 v[22:23], v[22:23], s[6:7], v[142:143]
    v_pk_mul_f32 v[18:19], v[18:19], v[16:17]
    v_pk_mul_f32 v[22:23], v[22:23], v[20:21]
    v_exp_f32 v18, v18
    v_exp_f32 v22, v22
    v_mfma_f32_32x32x16_bf16 v[72:87], v[160:163], v[132:135], v[72:87]
    buffer_load_dwordx4 v[160:163], v4, s[68:71], s90 offen offset:512 sc1
    v_exp_f32 v19, v19
    v_exp_f32 v23, v23
    s_nop 0
    v_pk_add_f32 v[18:19], v[18:19], s[8:9]
    v_pk_add_f32 v[22:23], v[22:23], s[8:9]
    v_rcp_f32 v18, v18
    v_rcp_f32 v22, v22
    v_mfma_f32_32x32x16_bf16 v[104:119], v[164:167], v[132:135], v[104:119]
    buffer_load_dwordx4 v[164:167], v4, s[68:71], s90 offen offset:1024 sc1
    v_rcp_f32 v19, v19
    v_rcp_f32 v23, v23
    s_nop 0
    v_pk_mul_f32 v[18:19], v[18:19], v[16:17]
    v_pk_mul_f32 v[22:23], v[22:23], v[20:21]
    v_cvt_pk_bf16_f32 v244, v18, v19
    v_cvt_pk_bf16_f32 v245, v22, v23
    s_waitcnt vmcnt(23) lgkmcnt(0)
    ds_read_b128 v[128:131], v10 offset:0
    ds_read_b128 v[132:135], v10 offset:4096
    v_mfma_f32_32x32x16_bf16 v[24:39], v[168:171], v[120:123], v[24:39]
    v_lshlrev_b32 v16, 16, v246
    v_lshlrev_b32 v20, 16, v247
    v_and_b32 v17, 0xffff0000, v246
    v_and_b32 v21, 0xffff0000, v247
    v_pk_mul_f32 v[18:19], v[16:17], v[16:17]
    v_pk_mul_f32 v[22:23], v[20:21], v[20:21]
    v_mfma_f32_32x32x16_bf16 v[56:71], v[172:175], v[120:123], v[56:71]
    v_pk_fma_f32 v[18:19], v[18:19], s[6:7], v[142:143]
    v_pk_fma_f32 v[22:23], v[22:23], s[6:7], v[142:143]
    v_pk_mul_f32 v[18:19], v[18:19], v[16:17]
    v_pk_mul_f32 v[22:23], v[22:23], v[20:21]
    v_exp_f32 v18, v18
    v_exp_f32 v22, v22
    v_mfma_f32_32x32x16_bf16 v[88:103], v[176:179], v[120:123], v[88:103]
    v_exp_f32 v19, v19
    v_exp_f32 v23, v23
    s_nop 0
    v_pk_add_f32 v[18:19], v[18:19], s[8:9]
    v_pk_add_f32 v[22:23], v[22:23], s[8:9]
    v_rcp_f32 v18, v18
    v_rcp_f32 v22, v22
    v_mfma_f32_32x32x16_bf16 v[40:55], v[168:171], v[124:127], v[40:55]
    s_add_u32 s90, s90, 3072
    buffer_load_dwordx4 v[168:171], v4, s[68:71], s90 offen offset:0 sc1
    v_rcp_f32 v19, v19
    v_rcp_f32 v23, v23
    s_nop 0
    v_pk_mul_f32 v[18:19], v[18:19], v[16:17]
    v_pk_mul_f32 v[22:23], v[22:23], v[20:21]
    v_cvt_pk_bf16_f32 v246, v18, v19
    v_cvt_pk_bf16_f32 v247, v22, v23
    v_mfma_f32_32x32x16_bf16 v[72:87], v[172:175], v[124:127], v[72:87]
    buffer_load_dwordx4 v[172:175], v4, s[68:71], s90 offen offset:512 sc1
    v_lshlrev_b32 v16, 16, v248
    v_lshlrev_b32 v20, 16, v249
    v_and_b32 v17, 0xffff0000, v248
    v_and_b32 v21, 0xffff0000, v249
    v_pk_mul_f32 v[18:19], v[16:17], v[16:17]
    v_pk_mul_f32 v[22:23], v[20:21], v[20:21]
    v_mfma_f32_32x32x16_bf16 v[104:119], v[176:179], v[124:127], v[104:119]
    buffer_load_dwordx4 v[176:179], v4, s[68:71], s90 offen offset:1024 sc1
    v_pk_fma_f32 v[18:19], v[18:19], s[6:7], v[142:143]
    v_pk_fma_f32 v[22:23], v[22:23], s[6:7], v[142:143]
    v_pk_mul_f32 v[18:19], v[18:19], v[16:17]
    v_pk_mul_f32 v[22:23], v[22:23], v[20:21]
    v_exp_f32 v18, v18
    v_exp_f32 v22, v22
    s_waitcnt vmcnt(23) lgkmcnt(0)
    v_mfma_f32_32x32x16_bf16 v[24:39], v[180:183], v[128:131], v[24:39]
    v_exp_f32 v19, v19
    v_exp_f32 v23, v23
    s_nop 0
    v_pk_add_f32 v[18:19], v[18:19], s[8:9]
    v_pk_add_f32 v[22:23], v[22:23], s[8:9]
    v_rcp_f32 v18, v18
    v_rcp_f32 v22, v22
    v_mfma_f32_32x32x16_bf16 v[56:71], v[184:187], v[128:131], v[56:71]
    v_rcp_f32 v19, v19
    v_rcp_f32 v23, v23
    s_nop 0
    v_pk_mul_f32 v[18:19], v[18:19], v[16:17]
    v_pk_mul_f32 v[22:23], v[22:23], v[20:21]
    v_cvt_pk_bf16_f32 v248, v18, v19
    v_cvt_pk_bf16_f32 v249, v22, v23
    v_mfma_f32_32x32x16_bf16 v[88:103], v[188:191], v[128:131], v[88:103]
    v_lshlrev_b32 v16, 16, v250
    v_lshlrev_b32 v20, 16, v251
    v_and_b32 v17, 0xffff0000, v250
    v_and_b32 v21, 0xffff0000, v251
    v_pk_mul_f32 v[18:19], v[16:17], v[16:17]
    v_pk_mul_f32 v[22:23], v[20:21], v[20:21]
    v_mfma_f32_32x32x16_bf16 v[40:55], v[180:183], v[132:135], v[40:55]
    s_add_u32 s90, s90, 3072
    buffer_load_dwordx4 v[180:183], v4, s[68:71], s90 offen offset:0 sc1
    v_pk_fma_f32 v[18:19], v[18:19], s[6:7], v[142:143]
    v_pk_fma_f32 v[22:23], v[22:23], s[6:7], v[142:143]
    v_pk_mul_f32 v[18:19], v[18:19], v[16:17]
    v_pk_mul_f32 v[22:23], v[22:23], v[20:21]
    v_exp_f32 v18, v18
    v_exp_f32 v22, v22
    v_mfma_f32_32x32x16_bf16 v[72:87], v[184:187], v[132:135], v[72:87]
    buffer_load_dwordx4 v[184:187], v4, s[68:71], s90 offen offset:512 sc1
    v_exp_f32 v19, v19
    v_exp_f32 v23, v23
    s_nop 0
    v_pk_add_f32 v[18:19], v[18:19], s[8:9]
    v_pk_add_f32 v[22:23], v[22:23], s[8:9]
    v_rcp_f32 v18, v18
    v_rcp_f32 v22, v22
    v_mfma_f32_32x32x16_bf16 v[104:119], v[188:191], v[132:135], v[104:119]
    buffer_load_dwordx4 v[188:191], v4, s[68:71], s90 offen offset:1024 sc1
    v_rcp_f32 v19, v19
    v_rcp_f32 v23, v23
    s_nop 0
    v_pk_mul_f32 v[18:19], v[18:19], v[16:17]
    v_pk_mul_f32 v[22:23], v[22:23], v[20:21]
    v_cvt_pk_bf16_f32 v250, v18, v19
    v_cvt_pk_bf16_f32 v251, v22, v23
    s_waitcnt vmcnt(38)
    ds_read_b128 v[120:123], v7 offset:8192
    ds_read_b128 v[124:127], v7 offset:12288
    v_cmp_eq_u32 s[84:85], s80, v140
    s_nop 3
    s_bitcmp1_b32 s84, 3
    s_cbranch_scc1 L_nb3_ok
    s_mov_b32 s93, 100000
L_nb3_spin:
    buffer_load_dword v140, v141, s[68:71], 0 offen sc1
    s_waitcnt vmcnt(0)
    v_cmp_eq_u32 s[84:85], s80, v140
    s_nop 3
    s_bitcmp1_b32 s84, 3
    s_cbranch_scc1 L_nb3_ok
    s_sleep 4
    s_sub_u32 s93, s93, 1
    s_cmp_lg_u32 s93, 0
    s_cbranch_scc1 L_nb3_spin
L_nb3_ok:
    buffer_load_dword v140, v141, s[68:71], 0 offen sc1
    s_waitcnt vmcnt(24) lgkmcnt(0)
    ds_read_b128 v[128:131], v8 offset:8192
    ds_read_b128 v[132:135], v8 offset:12288
    v_mfma_f32_32x32x16_bf16 v[24:39], v[192:195], v[120:123], v[24:39]
    s_and_b32 s5, s5, 31
    s_lshl_b32 s77, s5, 7
    s_add_u32 s77, s77, s94
    s_add_u32 s5, s5, 4
    s_add_u32 m0, s3, 0
    s_nop 0
    buffer_load_dwordx4 v2, s[60:63], s77 offen offset:0 lds
    s_add_u32 m0, s3, 0
    s_nop 0
    buffer_load_dwordx4 v3, s[60:63], s77 offen offset:1024 lds
    v_mfma_f32_32x32x16_bf16 v[56:71], v[196:199], v[120:123], v[56:71]
    s_add_u32 m0, s3, 0
    s_nop 0
    buffer_load_dwordx4 v15, s[60:63], s77 offen offset:2048 lds
    v_mfma_f32_32x32x16_bf16 v[88:103], v[200:203], v[120:123], v[88:103]
    s_add_u32 m0, s3, 0
    s_nop 0
    buffer_load_dwordx4 v0, s[60:63], s77 offen offset:3072 lds
    v_mfma_f32_32x32x16_bf16 v[40:55], v[192:195], v[124:127], v[40:55]
    s_and_b32 s10, s10, 31
    s_mul_i32 s90, s10, 12288
    s_add_u32 s90, s90, s95
    s_add_u32 s10, s10, 4
    buffer_load_dwordx4 v[192:195], v4, s[68:71], s90 offen offset:0 sc1
    v_mfma_f32_32x32x16_bf16 v[72:87], v[196:199], v[124:127], v[72:87]
    buffer_load_dwordx4 v[196:199], v4, s[68:71], s90 offen offset:512 sc1
    v_mfma_f32_32x32x16_bf16 v[104:119], v[200:203], v[124:127], v[104:119]
    buffer_load_dwordx4 v[200:203], v4, s[68:71], s90 offen offset:1024 sc1
    s_waitcnt vmcnt(28) lgkmcnt(0)
    ds_read_b128 v[120:123], v9 offset:8192
    ds_read_b128 v[124:127], v9 offset:12288
    v_mfma_f32_32x32x16_bf16 v[24:39], v[204:207], v[128:131], v[24:39]
    s_add_u32 s77, s77, 131072
    s_add_u32 m0, s3, 4096
    s_nop 0
    buffer_load_dwordx4 v2, s[60:63], s77 offen offset:0 lds
    s_add_u32 m0, s3, 4096
    s_nop 0
    buffer_load_dwordx4 v3, s[60:63], s77 offen offset:1024 lds
    v_mfma_f32_32x32x16_bf16 v[56:71], v[208:211], v[128:131], v[56:71]
    s_add_u32 m0, s3, 4096
    s_nop 0
    buffer_load_dwordx4 v15, s[60:63], s77 offen offset:2048 lds
    v_mfma_f32_32x32x16_bf16 v[88:103], v[212:215], v[128:131], v[88:103]
    s_add_u32 m0, s3, 4096
    s_nop 0
    buffer_load_dwordx4 v0, s[60:63], s77 offen offset:3072 lds
    v_mfma_f32_32x32x16_bf16 v[40:55], v[204:207], v[132:135], v[40:55]
    s_add_u32 s90, s90, 3072
    buffer_load_dwordx4 v[204:207], v4, s[68:71], s90 offen offset:0 sc1
    v_mfma_f32_32x32x16_bf16 v[72:87], v[208:211], v[132:135], v[72:87]
    buffer_load_dwordx4 v[208:211], v4, s[68:71], s90 offen offset:512 sc1
    v_mfma_f32_32x32x16_bf16 v[104:119], v[212:215], v[132:135], v[104:119]
    buffer_load_dwordx4 v[212:215], v4, s[68:71], s90 offen offset:1024 sc1
    s_waitcnt vmcnt(32) lgkmcnt(0)
    ds_read_b128 v[128:131], v10 offset:8192
    ds_read_b128 v[132:135], v10 offset:12288
    v_mfma_f32_32x32x16_bf16 v[24:39], v[216:219], v[120:123], v[24:39]
    v_mfma_f32_32x32x16_bf16 v[56:71], v[220:223], v[120:123], v[56:71]
    v_mfma_f32_32x32x16_bf16 v[88:103], v[224:227], v[120:123], v[88:103]
    v_mfma_f32_32x32x16_bf16 v[40:55], v[216:219], v[124:127], v[40:55]
    s_add_u32 s90, s90, 3072
    buffer_load_dwordx4 v[216:219], v4, s[68:71], s90 offen offset:0 sc1
    v_mfma_f32_32x32x16_bf16 v[72:87], v[220:223], v[124:127], v[72:87]
    buffer_load_dwordx4 v[220:223], v4, s[68:71], s90 offen offset:512 sc1
    v_mfma_f32_32x32x16_bf16 v[104:119], v[224:227], v[124:127], v[104:119]
    buffer_load_dwordx4 v[224:227], v4, s[68:71], s90 offen offset:1024 sc1
    s_waitcnt vmcnt(32) lgkmcnt(0)
    v_mfma_f32_32x32x16_bf16 v[24:39], v[228:231], v[128:131], v[24:39]
    v_mfma_f32_32x32x16_bf16 v[56:71], v[232:235], v[128:131], v[56:71]
    v_mfma_f32_32x32x16_bf16 v[88:103], v[236:239], v[128:131], v[88:103]
    v_mfma_f32_32x32x16_bf16 v[40:55], v[228:231], v[132:135], v[40:55]
    s_add_u32 s90, s90, 3072
    buffer_load_dwordx4 v[228:231], v4, s[68:71], s90 offen offset:0 sc1
    v_mfma_f32_32x32x16_bf16 v[72:87], v[232:235], v[132:135], v[72:87]
    buffer_load_dwordx4 v[232:235], v4, s[68:71], s90 offen offset:512 sc1
    v_mfma_f32_32x32x16_bf16 v[104:119], v[236:239], v[132:135], v[104:119]
    buffer_load_dwordx4 v[236:239], v4, s[68:71], s90 offen offset:1024 sc1
    s_waitcnt vmcnt(9)
    ds_read_b128 v[120:123], v7 offset:0
    ds_read_b128 v[124:127], v7 offset:4096
    v_cmp_eq_u32 s[84:85], s80, v140
    s_nop 3
    s_bitcmp1_b32 s84, 4
    s_cbranch_scc1 L_nb4_ok
    s_mov_b32 s93, 100000
L_nb4_spin:
    buffer_load_dword v140, v141, s[68:71], 0 offen sc1
    s_waitcnt vmcnt(0)
    v_cmp_eq_u32 s[84:85], s80, v140
    s_nop 3
    s_bitcmp1_b32 s84, 4
    s_cbranch_scc1 L_nb4_ok
    s_sleep 4
    s_sub_u32 s93, s93, 1
    s_cmp_lg_u32 s93, 0
    s_cbranch_scc1 L_nb4_spin
L_nb4_ok:
    buffer_load_dword v140, v141, s[68:71], 0 offen sc1
    s_waitcnt vmcnt(31) lgkmcnt(0)
    ds_read_b128 v[128:131], v8 offset:0
    ds_read_b128 v[132:135], v8 offset:4096
    v_mfma_f32_32x32x16_bf16 v[24:39], v[144:147], v[120:123], v[24:39]
    s_and_b32 s5, s5, 31
    s_lshl_b32 s77, s5, 7
    s_add_u32 s77, s77, s94
    s_add_u32 s5, s5, 4
    s_add_u32 m0, s3, 8192
    s_nop 0
    buffer_load_dwordx4 v2, s[60:63], s77 offen offset:0 lds
    s_add_u32 m0, s3, 8192
    s_nop 0
    buffer_load_dwordx4 v3, s[60:63], s77 offen offset:1024 lds
    v_mfma_f32_32x32x16_bf16 v[56:71], v[148:151], v[120:123], v[56:71]
    s_add_u32 m0, s3, 8192
    s_nop 0
    buffer_load_dwordx4 v15, s[60:63], s77 offen offset:2048 lds
    v_mfma_f32_32x32x16_bf16 v[88:103], v[152:155], v[120:123], v[88:103]
    s_add_u32 m0, s3, 8192
    s_nop 0
    buffer_load_dwordx4 v0, s[60:63], s77 offen offset:3072 lds
    v_mfma_f32_32x32x16_bf16 v[40:55], v[144:147], v[124:127], v[40:55]
    s_and_b32 s10, s10, 31
    s_mul_i32 s90, s10, 12288
    s_add_u32 s90, s90, s95
    s_add_u32 s10, s10, 4
    buffer_load_dwordx4 v[144:147], v4, s[68:71], s90 offen offset:0 sc1
    v_mfma_f32_32x32x16_bf16 v[72:87], v[148:151], v[124:127], v[72:87]
    buffer_load_dwordx4 v[148:151], v4, s[68:71], s90 offen offset:512 sc1
    v_mfma_f32_32x32x16_bf16 v[104:119], v[152:155], v[124:127], v[104:119]
    buffer_load_dwordx4 v[152:155], v4, s[68:71], s90 offen offset:1024 sc1
    s_waitcnt vmcnt(35) lgkmcnt(0)
    ds_read_b128 v[120:123], v9 offset:0
    ds_read_b128 v[124:127], v9 offset:4096
    v_mfma_f32_32x32x16_bf16 v[24:39], v[156:159], v[128:131], v[24:39]
    s_add_u32 s77, s77, 131072
    s_add_u32 m0, s3, 12288
    s_nop 0
    buffer_load_dwordx4 v2, s[60:63], s77 offen offset:0 lds
    s_add_u32 m0, s3, 12288
    s_nop 0
    buffer_load_dwordx4 v3, s[60:63], s77 offen offset:1024 lds
    v_mfma_f32_32x32x16_bf16 v[56:71], v[160:163], v[128:131], v[56:71]
    s_add_u32 m0, s3, 12288
    s_nop 0
    buffer_load_dwordx4 v15, s[60:63], s77 offen offset:2048 lds
    v_mfma_f32_32x32x16_bf16 v[88:103], v[164:167], v[128:131], v[88:103]
    s_add_u32 m0, s3, 12288
    s_nop 0
    buffer_load_dwordx4 v0, s[60:63], s77 offen offset:3072 lds
    v_mfma_f32_32x32x16_bf16 v[40:55], v[156:159], v[132:135], v[40:55]
    s_add_u32 s90, s90, 3072
    buffer_load_dwordx4 v[156:159], v4, s[68:71], s90 offen offset:0 sc1
    v_mfma_f32_32x32x16_bf16 v[72:87], v[160:163], v[132:135], v[72:87]
    buffer_load_dwordx4 v[160:163], v4, s[68:71], s90 offen offset:512 sc1
    v_mfma_f32_32x32x16_bf16 v[104:119], v[164:167], v[132:135], v[104:119]
    buffer_load_dwordx4 v[164:167], v4, s[68:71], s90 offen offset:1024 sc1
    s_waitcnt vmcnt(39) lgkmcnt(0)
    ds_read_b128 v[128:131], v10 offset:0
    ds_read_b128 v[132:135], v10 offset:4096
    v_mfma_f32_32x32x16_bf16 v[24:39], v[168:171], v[120:123], v[24:39]
    v_mfma_f32_32x32x16_bf16 v[56:71], v[172:175], v[120:123], v[56:71]
    v_mfma_f32_32x32x16_bf16 v[88:103], v[176:179], v[120:123], v[88:103]
    v_mfma_f32_32x32x16_bf16 v[40:55], v[168:171], v[124:127], v[40:55]
    s_add_u32 s90, s90, 3072
    buffer_load_dwordx4 v[168:171], v4, s[68:71], s90 offen offset:0 sc1
    v_mfma_f32_32x32x16_bf16 v[72:87], v[172:175], v[124:127], v[72:87]
    buffer_load_dwordx4 v[172:175], v4, s[68:71], s90 offen offset:512 sc1
    v_mfma_f32_32x32x16_bf16 v[104:119], v[176:179], v[124:127], v[104:119]
    buffer_load_dwordx4 v[176:179], v4, s[68:71], s90 offen offset:1024 sc1
    s_waitcnt vmcnt(39) lgkmcnt(0)
    v_mfma_f32_32x32x16_bf16 v[24:39], v[180:183], v[128:131], v[24:39]
    v_mfma_f32_32x32x16_bf16 v[56:71], v[184:187], v[128:131], v[56:71]
    v_mfma_f32_32x32x16_bf16 v[88:103], v[188:191], v[128:131], v[88:103]
    v_mfma_f32_32x32x16_bf16 v[40:55], v[180:183], v[132:135], v[40:55]
    s_add_u32 s90, s90, 3072
    buffer_load_dwordx4 v[180:183], v4, s[68:71], s90 offen offset:0 sc1
    v_mfma_f32_32x32x16_bf16 v[72:87], v[184:187], v[132:135], v[72:87]
    buffer_load_dwordx4 v[184:187], v4, s[68:71], s90 offen offset:512 sc1
    v_mfma_f32_32x32x16_bf16 v[104:119], v[188:191], v[132:135], v[104:119]
    buffer_load_dwordx4 v[188:191], v4, s[68:71], s90 offen offset:1024 sc1
    s_waitcnt vmcnt(9)
    ds_read_b128 v[120:123], v7 offset:8192
    ds_read_b128 v[124:127], v7 offset:12288
    v_cmp_eq_u32 s[84:85], s80, v140
    s_nop 3
    s_bitcmp1_b32 s84, 5
    s_cbranch_scc1 L_nb5_ok
    s_mov_b32 s93, 100000
L_nb5_spin:
    buffer_load_dword v140, v141, s[68:71], 0 offen sc1
    s_waitcnt vmcnt(0)
    v_cmp_eq_u32 s[84:85], s80, v140
    s_nop 3
    s_bitcmp1_b32 s84, 5
    s_cbranch_scc1 L_nb5_ok
    s_sleep 4
    s_sub_u32 s93, s93, 1
    s_cmp_lg_u32 s93, 0
    s_cbranch_scc1 L_nb5_spin
L_nb5_ok:
    buffer_load_dword v140, v141, s[68:71], 0 offen sc1
    s_waitcnt vmcnt(35) lgkmcnt(0)
    ds_read_b128 v[128:131], v8 offset:8192
    ds_read_b128 v[132:135], v8 offset:12288
    v_mfma_f32_32x32x16_bf16 v[24:39], v[192:195], v[120:123], v[24:39]
    s_and_b32 s5, s5, 31
    s_lshl_b32 s77, s5, 7
    s_add_u32 s77, s77, s94
    s_add_u32 s5, s5, 4
    s_add_u32 m0, s3, 0
    s_nop 0
    buffer_load_dwordx4 v2, s[60:63], s77 offen offset:0 lds
    s_add_u32 m0, s3, 0
    s_nop 0
    buffer_load_dwordx4 v3, s[60:63], s77 offen offset:1024 lds
    v_mfma_f32_32x32x16_bf16 v[56:71], v[196:199], v[120:123], v[56:71]
    s_add_u32 m0, s3, 0
    s_nop 0
    buffer_load_dwordx4 v15, s[60:63], s77 offen offset:2048 lds
    v_mfma_f32_32x32x16_bf16 v[88:103], v[200:203], v[120:123], v[88:103]
    s_add_u32 m0, s3, 0
    s_nop 0
    buffer_load_dwordx4 v0, s[60:63], s77 offen offset:3072 lds
    v_mfma_f32_32x32x16_bf16 v[40:55], v[192:195], v[124:127], v[40:55]
    s_and_b32 s10, s10, 31
    s_mul_i32 s90, s10, 12288
    s_add_u32 s90, s90, s95
    s_add_u32 s10, s10, 4
    buffer_load_dwordx4 v[192:195], v4, s[68:71], s90 offen offset:0 sc1
    v_mfma_f32_32x32x16_bf16 v[72:87], v[196:199], v[124:127], v[72:87]
    buffer_load_dwordx4 v[196:199], v4, s[68:71], s90 offen offset:512 sc1
    v_mfma_f32_32x32x16_bf16 v[104:119], v[200:203], v[124:127], v[104:119]
    buffer_load_dwordx4 v[200:203], v4, s[68:71], s90 offen offset:1024 sc1
    s_waitcnt vmcnt(35) lgkmcnt(0)
    ds_read_b128 v[120:123], v9 offset:8192
    ds_read_b128 v[124:127], v9 offset:12288
    v_mfma_f32_32x32x16_bf16 v[24:39], v[204:207], v[128:131], v[24:39]
    s_add_u32 s77, s77, 131072
    s_add_u32 m0, s3, 4096
    s_nop 0
    buffer_load_dwordx4 v2, s[60:63], s77 offen offset:0 lds
    s_add_u32 m0, s3, 4096
    s_nop 0
    buffer_load_dwordx4 v3, s[60:63], s77 offen offset:1024 lds
    v_mfma_f32_32x32x16_bf16 v[56:71], v[208:211], v[128:131], v[56:71]
    s_add_u32 m0, s3, 4096
    s_nop 0
    buffer_load_dwordx4 v15, s[60:63], s77 offen offset:2048 lds
    v_mfma_f32_32x32x16_bf16 v[88:103], v[212:215], v[128:131], v[88:103]
    s_add_u32 m0, s3, 4096
    s_nop 0
    buffer_load_dwordx4 v0, s[60:63], s77 offen offset:3072 lds
    v_mfma_f32_32x32x16_bf16 v[40:55], v[204:207], v[132:135], v[40:55]
    s_add_u32 s90, s90, 3072
    buffer_load_dwordx4 v[204:207], v4, s[68:71], s90 offen offset:0 sc1
    v_mfma_f32_32x32x16_bf16 v[72:87], v[208:211], v[132:135], v[72:87]
    buffer_load_dwordx4 v[208:211], v4, s[68:71], s90 offen offset:512 sc1
    v_mfma_f32_32x32x16_bf16 v[104:119], v[212:215], v[132:135], v[104:119]
    buffer_load_dwordx4 v[212:215], v4, s[68:71], s90 offen offset:1024 sc1
    s_waitcnt vmcnt(39) lgkmcnt(0)
    ds_read_b128 v[128:131], v10 offset:8192
    ds_read_b128 v[132:135], v10 offset:12288
    v_mfma_f32_32x32x16_bf16 v[24:39], v[216:219], v[120:123], v[24:39]
    v_mfma_f32_32x32x16_bf16 v[56:71], v[220:223], v[120:123], v[56:71]
    v_mfma_f32_32x32x16_bf16 v[88:103], v[224:227], v[120:123], v[88:103]
    v_mfma_f32_32x32x16_bf16 v[40:55], v[216:219], v[124:127], v[40:55]
    s_add_u32 s90, s90, 3072
    buffer_load_dwordx4 v[216:219], v4, s[68:71], s90 offen offset:0 sc1
    v_mfma_f32_32x32x16_bf16 v[72:87], v[220:223], v[124:127], v[72:87]
    buffer_load_dwordx4 v[220:223], v4, s[68:71], s90 offen offset:512 sc1
    v_mfma_f32_32x32x16_bf16 v[104:119], v[224:227], v[124:127], v[104:119]
    buffer_load_dwordx4 v[224:227], v4, s[68:71], s90 offen offset:1024 sc1
    s_waitcnt vmcnt(39) lgkmcnt(0)
    v_mfma_f32_32x32x16_bf16 v[24:39], v[228:231], v[128:131], v[24:39]
    v_mfma_f32_32x32x16_bf16 v[56:71], v[232:235], v[128:131], v[56:71]
    v_mfma_f32_32x32x16_bf16 v[88:103], v[236:239], v[128:131], v[88:103]
    v_mfma_f32_32x32x16_bf16 v[40:55], v[228:231], v[132:135], v[40:55]
    s_add_u32 s90, s90, 3072
    buffer_load_dwordx4 v[228:231], v4, s[68:71], s90 offen offset:0 sc1
    v_mfma_f32_32x32x16_bf16 v[72:87], v[232:235], v[132:135], v[72:87]
    buffer_load_dwordx4 v[232:235], v4, s[68:71], s90 offen offset:512 sc1
    v_mfma_f32_32x32x16_bf16 v[104:119], v[236:239], v[132:135], v[104:119]
    buffer_load_dwordx4 v[236:239], v4, s[68:71], s90 offen offset:1024 sc1
    s_waitcnt vmcnt(9)
    ds_read_b128 v[120:123], v7 offset:0
    ds_read_b128 v[124:127], v7 offset:4096
    v_cmp_eq_u32 s[84:85], s80, v140
    s_nop 3
    s_bitcmp1_b32 s84, 6
    s_cbranch_scc1 L_nb6_ok
    s_mov_b32 s93, 100000
L_nb6_spin:
    buffer_load_dword v140, v141, s[68:71], 0 offen sc1
    s_waitcnt vmcnt(0)
    v_cmp_eq_u32 s[84:85], s80, v140
    s_nop 3
    s_bitcmp1_b32 s84, 6
    s_cbranch_scc1 L_nb6_ok
    s_sleep 4
    s_sub_u32 s93, s93, 1
    s_cmp_lg_u32 s93, 0
    s_cbranch_scc1 L_nb6_spin
L_nb6_ok:
    buffer_load_dword v140, v141, s[68:71], 0 offen sc1
    s_waitcnt vmcnt(35) lgkmcnt(0)
    ds_read_b128 v[128:131], v8 offset:0
    ds_read_b128 v[132:135], v8 offset:4096
    v_mfma_f32_32x32x16_bf16 v[24:39], v[144:147], v[120:123], v[24:39]
    s_and_b32 s5, s5, 31
    s_lshl_b32 s77, s5, 7
    s_add_u32 s77, s77, s94
    s_add_u32 s5, s5, 4
    s_add_u32 m0, s3, 8192
    s_nop 0
    buffer_load_dwordx4 v2, s[60:63], s77 offen offset:0 lds
    s_add_u32 m0, s3, 8192
    s_nop 0
    buffer_load_dwordx4 v3, s[60:63], s77 offen offset:1024 lds
    v_mfma_f32_32x32x16_bf16 v[56:71], v[148:151], v[120:123], v[56:71]
    s_add_u32 m0, s3, 8192
    s_nop 0
    buffer_load_dwordx4 v15, s[60:63], s77 offen offset:2048 lds
    v_mfma_f32_32x32x16_bf16 v[88:103], v[152:155], v[120:123], v[88:103]
    s_add_u32 m0, s3, 8192
    s_nop 0
    buffer_load_dwordx4 v0, s[60:63], s77 offen offset:3072 lds
    v_mfma_f32_32x32x16_bf16 v[40:55], v[144:147], v[124:127], v[40:55]
    s_and_b32 s10, s10, 31
    s_mul_i32 s90, s10, 12288
    s_add_u32 s90, s90, s95
    s_add_u32 s10, s10, 4
    buffer_load_dwordx4 v[144:147], v4, s[68:71], s90 offen offset:0 sc1
    v_mfma_f32_32x32x16_bf16 v[72:87], v[148:151], v[124:127], v[72:87]
    buffer_load_dwordx4 v[148:151], v4, s[68:71], s90 offen offset:512 sc1
    v_mfma_f32_32x32x16_bf16 v[104:119], v[152:155], v[124:127], v[104:119]
    buffer_load_dwordx4 v[152:155], v4, s[68:71], s90 offen offset:1024 sc1
    s_waitcnt vmcnt(35) lgkmcnt(0)
    ds_read_b128 v[120:123], v9 offset:0
    ds_read_b128 v[124:127], v9 offset:4096
    v_mfma_f32_32x32x16_bf16 v[24:39], v[156:159], v[128:131], v[24:39]
    s_add_u32 s77, s77, 131072
    s_add_u32 m0, s3, 12288
    s_nop 0
    buffer_load_dwordx4 v2, s[60:63], s77 offen offset:0 lds
    s_add_u32 m0, s3, 12288
    s_nop 0
    buffer_load_dwordx4 v3, s[60:63], s77 offen offset:1024 lds
    v_mfma_f32_32x32x16_bf16 v[56:71], v[160:163], v[128:131], v[56:71]
    s_add_u32 m0, s3, 12288
    s_nop 0
    buffer_load_dwordx4 v15, s[60:63], s77 offen offset:2048 lds
    v_mfma_f32_32x32x16_bf16 v[88:103], v[164:167], v[128:131], v[88:103]
    s_add_u32 m0, s3, 12288
    s_nop 0
    buffer_load_dwordx4 v0, s[60:63], s77 offen offset:3072 lds
    v_mfma_f32_32x32x16_bf16 v[40:55], v[156:159], v[132:135], v[40:55]
    s_add_u32 s90, s90, 3072
    buffer_load_dwordx4 v[156:159], v4, s[68:71], s90 offen offset:0 sc1
    v_mfma_f32_32x32x16_bf16 v[72:87], v[160:163], v[132:135], v[72:87]
    buffer_load_dwordx4 v[160:163], v4, s[68:71], s90 offen offset:512 sc1
    v_mfma_f32_32x32x16_bf16 v[104:119], v[164:167], v[132:135], v[104:119]
    buffer_load_dwordx4 v[164:167], v4, s[68:71], s90 offen offset:1024 sc1
    s_waitcnt vmcnt(39) lgkmcnt(0)
    ds_read_b128 v[128:131], v10 offset:0
    ds_read_b128 v[132:135], v10 offset:4096
    v_mfma_f32_32x32x16_bf16 v[24:39], v[168:171], v[120:123], v[24:39]
    v_mfma_f32_32x32x16_bf16 v[56:71], v[172:175], v[120:123], v[56:71]
    v_mfma_f32_32x32x16_bf16 v[88:103], v[176:179], v[120:123], v[88:103]
    v_mfma_f32_32x32x16_bf16 v[40:55], v[168:171], v[124:127], v[40:55]
    s_add_u32 s90, s90, 3072
    buffer_load_dwordx4 v[168:171], v4, s[68:71], s90 offen offset:0 sc1
    v_mfma_f32_32x32x16_bf16 v[72:87], v[172:175], v[124:127], v[72:87]
    buffer_load_dwordx4 v[172:175], v4, s[68:71], s90 offen offset:512 sc1
    v_mfma_f32_32x32x16_bf16 v[104:119], v[176:179], v[124:127], v[104:119]
    buffer_load_dwordx4 v[176:179], v4, s[68:71], s90 offen offset:1024 sc1
    s_waitcnt vmcnt(39) lgkmcnt(0)
    v_mfma_f32_32x32x16_bf16 v[24:39], v[180:183], v[128:131], v[24:39]
    v_mfma_f32_32x32x16_bf16 v[56:71], v[184:187], v[128:131], v[56:71]
    v_mfma_f32_32x32x16_bf16 v[88:103], v[188:191], v[128:131], v[88:103]
    v_mfma_f32_32x32x16_bf16 v[40:55], v[180:183], v[132:135], v[40:55]
    s_add_u32 s90, s90, 3072
    buffer_load_dwordx4 v[180:183], v4, s[68:71], s90 offen offset:0 sc1
    v_mfma_f32_32x32x16_bf16 v[72:87], v[184:187], v[132:135], v[72:87]
    buffer_load_dwordx4 v[184:187], v4, s[68:71], s90 offen offset:512 sc1
    v_mfma_f32_32x32x16_bf16 v[104:119], v[188:191], v[132:135], v[104:119]
    buffer_load_dwordx4 v[188:191], v4, s[68:71], s90 offen offset:1024 sc1
    s_waitcnt vmcnt(9)
    ds_read_b128 v[120:123], v7 offset:8192
    ds_read_b128 v[124:127], v7 offset:12288
    v_cmp_eq_u32 s[84:85], s80, v140
    s_nop 3
    s_bitcmp1_b32 s84, 7
    s_cbranch_scc1 L_nb7_ok
    s_mov_b32 s93, 100000
L_nb7_spin:
    buffer_load_dword v140, v141, s[68:71], 0 offen sc1
    s_waitcnt vmcnt(0)
    v_cmp_eq_u32 s[84:85], s80, v140
    s_nop 3
    s_bitcmp1_b32 s84, 7
    s_cbranch_scc1 L_nb7_ok
    s_sleep 4
    s_sub_u32 s93, s93, 1
    s_cmp_lg_u32 s93, 0
    s_cbranch_scc1 L_nb7_spin
L_nb7_ok:
    s_waitcnt vmcnt(34) lgkmcnt(0)
    ds_read_b128 v[128:131], v8 offset:8192
    ds_read_b128 v[132:135], v8 offset:12288
    v_mfma_f32_32x32x16_bf16 v[24:39], v[192:195], v[120:123], v[24:39]
    s_and_b32 s5, s5, 31
    s_lshl_b32 s77, s5, 7
    s_add_u32 s77, s77, s94
    s_add_u32 s5, s5, 4
    s_add_u32 m0, s3, 0
    s_nop 0
    buffer_load_dwordx4 v2, s[60:63], s77 offen offset:0 lds
    s_add_u32 m0, s3, 0
    s_nop 0
    buffer_load_dwordx4 v3, s[60:63], s77 offen offset:1024 lds
    v_mfma_f32_32x32x16_bf16 v[56:71], v[196:199], v[120:123], v[56:71]
    s_add_u32 m0, s3, 0
    s_nop 0
    buffer_load_dwordx4 v15, s[60:63], s77 offen offset:2048 lds
    v_mfma_f32_32x32x16_bf16 v[88:103], v[200:203], v[120:123], v[88:103]
    s_add_u32 m0, s3, 0
    s_nop 0
    buffer_load_dwordx4 v0, s[60:63], s77 offen offset:3072 lds
    v_mfma_f32_32x32x16_bf16 v[40:55], v[192:195], v[124:127], v[40:55]
    s_and_b32 s10, s10, 31
    s_mul_i32 s90, s10, 12288
    s_add_u32 s90, s90, s95
    s_add_u32 s10, s10, 4
    buffer_load_dwordx4 v[192:195], v4, s[68:71], s90 offen offset:0 sc1
    v_mfma_f32_32x32x16_bf16 v[72:87], v[196:199], v[124:127], v[72:87]
    buffer_load_dwordx4 v[196:199], v4, s[68:71], s90 offen offset:512 sc1
    v_mfma_f32_32x32x16_bf16 v[104:119], v[200:203], v[124:127], v[104:119]
    buffer_load_dwordx4 v[200:203], v4, s[68:71], s90 offen offset:1024 sc1
    s_waitcnt vmcnt(34) lgkmcnt(0)
    ds_read_b128 v[120:123], v9 offset:8192
    ds_read_b128 v[124:127], v9 offset:12288
    v_mfma_f32_32x32x16_bf16 v[24:39], v[204:207], v[128:131], v[24:39]
    s_add_u32 s77, s77, 131072
    s_add_u32 m0, s3, 4096
    s_nop 0
    buffer_load_dwordx4 v2, s[60:63], s77 offen offset:0 lds
    s_add_u32 m0, s3, 4096
    s_nop 0
    buffer_load_dwordx4 v3, s[60:63], s77 offen offset:1024 lds
    v_mfma_f32_32x32x16_bf16 v[56:71], v[208:211], v[128:131], v[56:71]
    s_add_u32 m0, s3, 4096
    s_nop 0
    buffer_load_dwordx4 v15, s[60:63], s77 offen offset:2048 lds
    v_mfma_f32_32x32x16_bf16 v[88:103], v[212:215], v[128:131], v[88:103]
    s_add_u32 m0, s3, 4096
    s_nop 0
    buffer_load_dwordx4 v0, s[60:63], s77 offen offset:3072 lds
    v_mfma_f32_32x32x16_bf16 v[40:55], v[204:207], v[132:135], v[40:55]
    s_add_u32 s90, s90, 3072
    buffer_load_dwordx4 v[204:207], v4, s[68:71], s90 offen offset:0 sc1
    v_mfma_f32_32x32x16_bf16 v[72:87], v[208:211], v[132:135], v[72:87]
    buffer_load_dwordx4 v[208:211], v4, s[68:71], s90 offen offset:512 sc1
    v_mfma_f32_32x32x16_bf16 v[104:119], v[212:215], v[132:135], v[104:119]
    buffer_load_dwordx4 v[212:215], v4, s[68:71], s90 offen offset:1024 sc1
    s_waitcnt vmcnt(38) lgkmcnt(0)
    ds_read_b128 v[128:131], v10 offset:8192
    ds_read_b128 v[132:135], v10 offset:12288
    v_mfma_f32_32x32x16_bf16 v[24:39], v[216:219], v[120:123], v[24:39]
    v_mfma_f32_32x32x16_bf16 v[56:71], v[220:223], v[120:123], v[56:71]
    v_mfma_f32_32x32x16_bf16 v[88:103], v[224:227], v[120:123], v[88:103]
    v_mfma_f32_32x32x16_bf16 v[40:55], v[216:219], v[124:127], v[40:55]
    s_add_u32 s90, s90, 3072
    buffer_load_dwordx4 v[216:219], v4, s[68:71], s90 offen offset:0 sc1
    v_mfma_f32_32x32x16_bf16 v[72:87], v[220:223], v[124:127], v[72:87]
    buffer_load_dwordx4 v[220:223], v4, s[68:71], s90 offen offset:512 sc1
    v_mfma_f32_32x32x16_bf16 v[104:119], v[224:227], v[124:127], v[104:119]
    buffer_load_dwordx4 v[224:227], v4, s[68:71], s90 offen offset:1024 sc1
    s_waitcnt vmcnt(38) lgkmcnt(0)
    v_mfma_f32_32x32x16_bf16 v[24:39], v[228:231], v[128:131], v[24:39]
    v_mfma_f32_32x32x16_bf16 v[56:71], v[232:235], v[128:131], v[56:71]
    v_mfma_f32_32x32x16_bf16 v[88:103], v[236:239], v[128:131], v[88:103]
    v_mfma_f32_32x32x16_bf16 v[40:55], v[228:231], v[132:135], v[40:55]
    s_add_u32 s90, s90, 3072
    buffer_load_dwordx4 v[228:231], v4, s[68:71], s90 offen offset:0 sc1
    v_mfma_f32_32x32x16_bf16 v[72:87], v[232:235], v[132:135], v[72:87]
    buffer_load_dwordx4 v[232:235], v4, s[68:71], s90 offen offset:512 sc1
    v_mfma_f32_32x32x16_bf16 v[104:119], v[236:239], v[132:135], v[104:119]
    buffer_load_dwordx4 v[236:239], v4, s[68:71], s90 offen offset:1024 sc1
    s_waitcnt vmcnt(9)
    ds_read_b128 v[120:123], v7 offset:0
    ds_read_b128 v[124:127], v7 offset:4096
    buffer_load_dword v140, v141, s[68:71], 0 offen sc1
    s_waitcnt vmcnt(34) lgkmcnt(0)
    ds_read_b128 v[128:131], v8 offset:0
    ds_read_b128 v[132:135], v8 offset:4096
    v_mfma_f32_32x32x16_bf16 v[24:39], v[144:147], v[120:123], v[24:39]
    s_and_b32 s5, s5, 31
    s_lshl_b32 s77, s5, 7
    s_add_u32 s77, s77, s94
    s_add_u32 s5, s5, 4
    s_add_u32 m0, s3, 8192
    s_nop 0
    buffer_load_dwordx4 v2, s[60:63], s77 offen offset:0 lds
    s_add_u32 m0, s3, 8192
    s_nop 0
    buffer_load_dwordx4 v3, s[60:63], s77 offen offset:1024 lds
    v_mfma_f32_32x32x16_bf16 v[56:71], v[148:151], v[120:123], v[56:71]
    s_add_u32 m0, s3, 8192
    s_nop 0
    buffer_load_dwordx4 v15, s[60:63], s77 offen offset:2048 lds
    v_mfma_f32_32x32x16_bf16 v[88:103], v[152:155], v[120:123], v[88:103]
    s_add_u32 m0, s3, 8192
    s_nop 0
    buffer_load_dwordx4 v0, s[60:63], s77 offen offset:3072 lds
    v_mfma_f32_32x32x16_bf16 v[40:55], v[144:147], v[124:127], v[40:55]
    v_mfma_f32_32x32x16_bf16 v[72:87], v[148:151], v[124:127], v[72:87]
    v_mfma_f32_32x32x16_bf16 v[104:119], v[152:155], v[124:127], v[104:119]
    s_waitcnt vmcnt(31) lgkmcnt(0)
    ds_read_b128 v[120:123], v9 offset:0
    ds_read_b128 v[124:127], v9 offset:4096
    v_mfma_f32_32x32x16_bf16 v[24:39], v[156:159], v[128:131], v[24:39]
    s_add_u32 s77, s77, 131072
    s_add_u32 m0, s3, 12288
    s_nop 0
    buffer_load_dwordx4 v2, s[60:63], s77 offen offset:0 lds
    s_add_u32 m0, s3, 12288
    s_nop 0
    buffer_load_dwordx4 v3, s[60:63], s77 offen offset:1024 lds
    v_mfma_f32_32x32x16_bf16 v[56:71], v[160:163], v[128:131], v[56:71]
    s_add_u32 m0, s3, 12288
    s_nop 0
    buffer_load_dwordx4 v15, s[60:63], s77 offen offset:2048 lds
    v_mfma_f32_32x32x16_bf16 v[88:103], v[164:167], v[128:131], v[88:103]
    s_add_u32 m0, s3, 12288
    s_nop 0
    buffer_load_dwordx4 v0, s[60:63], s77 offen offset:3072 lds
    v_mfma_f32_32x32x16_bf16 v[40:55], v[156:159], v[132:135], v[40:55]
    v_mfma_f32_32x32x16_bf16 v[72:87], v[160:163], v[132:135], v[72:87]
    v_mfma_f32_32x32x16_bf16 v[104:119], v[164:167], v[132:135], v[104:119]
    s_waitcnt vmcnt(32) lgkmcnt(0)
    ds_read_b128 v[128:131], v10 offset:0
    ds_read_b128 v[132:135], v10 offset:4096
    v_mfma_f32_32x32x16_bf16 v[24:39], v[168:171], v[120:123], v[24:39]
    v_mfma_f32_32x32x16_bf16 v[56:71], v[172:175], v[120:123], v[56:71]
    v_mfma_f32_32x32x16_bf16 v[88:103], v[176:179], v[120:123], v[88:103]
    v_mfma_f32_32x32x16_bf16 v[40:55], v[168:171], v[124:127], v[40:55]
    v_mfma_f32_32x32x16_bf16 v[72:87], v[172:175], v[124:127], v[72:87]
    v_mfma_f32_32x32x16_bf16 v[104:119], v[176:179], v[124:127], v[104:119]
    s_waitcnt vmcnt(29) lgkmcnt(0)
    v_mfma_f32_32x32x16_bf16 v[24:39], v[180:183], v[128:131], v[24:39]
    v_mfma_f32_32x32x16_bf16 v[56:71], v[184:187], v[128:131], v[56:71]
    v_mfma_f32_32x32x16_bf16 v[88:103], v[188:191], v[128:131], v[88:103]
    v_mfma_f32_32x32x16_bf16 v[40:55], v[180:183], v[132:135], v[40:55]
    v_mfma_f32_32x32x16_bf16 v[72:87], v[184:187], v[132:135], v[72:87]
    v_mfma_f32_32x32x16_bf16 v[104:119], v[188:191], v[132:135], v[104:119]
    s_waitcnt vmcnt(0)
    ds_read_b128 v[120:123], v7 offset:8192
    ds_read_b128 v[124:127], v7 offset:12288
L_p2_tail1:
    ds_read_b128 v[128:131], v8 offset:8192
    ds_read_b128 v[132:135], v8 offset:12288
    ds_read_b128 v[184:187], v9 offset:8192
    ds_read_b128 v[188:191], v9 offset:12288
    ds_read_b128 v[16:19], v10 offset:8192
    ds_read_b128 v[20:23], v10 offset:12288
    s_waitcnt vmcnt(0) lgkmcnt(0)
    v_cmp_eq_u32 s[84:85], s80, v140
    s_nop 3
    s_andn2_b32 s92, 16128, s84
    s_cbranch_scc0 L_nb8_ok
    s_mov_b32 s93, 100000
L_nb8_spin:
    buffer_load_dword v140, v141, s[68:71], 0 offen sc1
    s_waitcnt vmcnt(0)
    v_cmp_eq_u32 s[84:85], s80, v140
    s_nop 3
    s_andn2_b32 s92, 16128, s84
    s_cbranch_scc0 L_nb8_ok
    s_sleep 4
    s_sub_u32 s93, s93, 1
    s_cmp_lg_u32 s93, 0
    s_cbranch_scc1 L_nb8_spin
L_nb8_ok:
    v_mfma_f32_32x32x16_bf16 v[24:39], v[192:195], v[120:123], v[24:39]
    s_add_u32 s90, s76, 0
    buffer_load_dwordx4 v[144:147], v5, s[68:71], s90 offen offset:0 sc1
    v_mfma_f32_32x32x16_bf16 v[24:39], v[204:207], v[128:131], v[24:39]
    v_mfma_f32_32x32x16_bf16 v[24:39], v[216:219], v[184:187], v[24:39]
    buffer_load_dwordx4 v[148:151], v5, s[68:71], s90 offen offset:1024 sc1
    v_mfma_f32_32x32x16_bf16 v[24:39], v[228:231], v[16:19], v[24:39]
    v_mfma_f32_32x32x16_bf16 v[40:55], v[192:195], v[124:127], v[40:55]
    buffer_load_dwordx4 v[152:155], v5, s[68:71], s90 offen offset:2048 sc1
    v_mfma_f32_32x32x16_bf16 v[40:55], v[204:207], v[132:135], v[40:55]
    v_mfma_f32_32x32x16_bf16 v[40:55], v[216:219], v[188:191], v[40:55]
    buffer_load_dwordx4 v[156:159], v5, s[68:71], s90 offen offset:3072 sc1
    s_nop 6
    ds_write_b128 v6, v[28:31] offset:0
    ds_write_b128 v6, v[32:35] offset:6144
    ds_write_b128 v6, v[36:39] offset:12288
    v_mfma_f32_32x32x16_bf16 v[40:55], v[228:231], v[20:23], v[40:55]
    v_mfma_f32_32x32x16_bf16 v[56:71], v[196:199], v[120:123], v[56:71]
    s_add_u32 s90, s76, 4096
    buffer_load_dwordx4 v[160:163], v5, s[68:71], s90 offen offset:0 sc1
    v_mfma_f32_32x32x16_bf16 v[56:71], v[208:211], v[128:131], v[56:71]
    v_mfma_f32_32x32x16_bf16 v[56:71], v[220:223], v[184:187], v[56:71]
    s_add_u32 s90, s76, 5120
    buffer_load_dwordx4 v[164:167], v5, s[68:71], s90 offen offset:0 sc1
    s_nop 4
    ds_write_b128 v6, v[44:47] offset:1024
    ds_write_b128 v6, v[48:51] offset:7168
    ds_write_b128 v6, v[52:55] offset:13312
    v_mfma_f32_32x32x16_bf16 v[56:71], v[232:235], v[16:19], v[56:71]
    v_mfma_f32_32x32x16_bf16 v[72:87], v[196:199], v[124:127], v[72:87]
    buffer_load_dwordx4 v[168:171], v5, s[68:71], s90 offen offset:1024 sc1
    v_mfma_f32_32x32x16_bf16 v[72:87], v[208:211], v[132:135], v[72:87]
    v_mfma_f32_32x32x16_bf16 v[72:87], v[220:223], v[188:191], v[72:87]
    buffer_load_dwordx4 v[172:175], v5, s[68:71], s90 offen offset:2048 sc1
    s_nop 6
    ds_write_b128 v6, v[60:63] offset:2048
    ds_write_b128 v6, v[64:67] offset:8192
    ds_write_b128 v6, v[68:71] offset:14336
    v_mfma_f32_32x32x16_bf16 v[72:87], v[232:235], v[20:23], v[72:87]
    v_mfma_f32_32x32x16_bf16 v[88:103], v[200:203], v[120:123], v[88:103]
    buffer_load_dwordx4 v[176:179], v5, s[68:71], s90 offen offset:3072 sc1
    v_mfma_f32_32x32x16_bf16 v[88:103], v[212:215], v[128:131], v[88:103]
    v_mfma_f32_32x32x16_bf16 v[88:103], v[224:227], v[184:187], v[88:103]
    s_add_u32 s90, s76, 9216
    buffer_load_dwordx4 v[180:183], v5, s[68:71], s90 offen offset:0 sc1
    s_nop 5
    ds_write_b128 v6, v[76:79] offset:3072
    ds_write_b128 v6, v[80:83] offset:9216
    ds_write_b128 v6, v[84:87] offset:15360
    v_mfma_f32_32x32x16_bf16 v[88:103], v[236:239], v[16:19], v[88:103]
    v_mfma_f32_32x32x16_bf16 v[104:119], v[200:203], v[124:127], v[104:119]
    v_mfma_f32_32x32x16_bf16 v[104:119], v[212:215], v[132:135], v[104:119]
    v_mfma_f32_32x32x16_bf16 v[104:119], v[224:227], v[188:191], v[104:119]
    s_nop 8
    ds_write_b128 v6, v[92:95] offset:4096
    ds_write_b128 v6, v[96:99] offset:10240
    ds_write_b128 v6, v[100:103] offset:16384
    v_mfma_f32_32x32x16_bf16 v[104:119], v[236:239], v[20:23], v[104:119]
    s_nop 11
    ds_write_b128 v6, v[108:111] offset:5120
    ds_write_b128 v6, v[112:115] offset:11264
    ds_write_b128 v6, v[116:119] offset:17408
    s_add_u32 s90, s76, 10240
    buffer_load_dwordx4 v[192:195], v5, s[68:71], s90 offen offset:0 sc1
    buffer_load_dwordx4 v[196:199], v5, s[68:71], s90 offen offset:1024 sc1
    buffer_load_dwordx4 v[200:203], v5, s[68:71], s90 offen offset:2048 sc1
    buffer_load_dwordx4 v[204:207], v5, s[68:71], s90 offen offset:3072 sc1
    s_add_u32 s90, s76, 14336
    buffer_load_dwordx4 v[208:211], v5, s[68:71], s90 offen offset:0 sc1
    s_add_u32 s90, s76, 15360
    buffer_load_dwordx4 v[212:215], v5, s[68:71], s90 offen offset:0 sc1
    buffer_load_dwordx4 v[216:219], v5, s[68:71], s90 offen offset:1024 sc1
    buffer_load_dwordx4 v[220:223], v5, s[68:71], s90 offen offset:2048 sc1
    buffer_load_dwordx4 v[224:227], v5, s[68:71], s90 offen offset:3072 sc1
    s_add_u32 s90, s76, 19456
    buffer_load_dwordx4 v[228:231], v5, s[68:71], s90 offen offset:0 sc1
L_red_done:
    s_waitcnt lgkmcnt(0)
    s_barrier
    ds_read_b128 v[28:31], v12 offset:0
    ds_read_b128 v[32:35], v13 offset:0
    ds_read_b128 v[36:39], v14 offset:0
    ds_read_b128 v[44:47], v12 offset:1024
    ds_read_b128 v[48:51], v13 offset:1024
    ds_read_b128 v[52:55], v14 offset:1024
    ds_read_b128 v[60:63], v12 offset:2048
    ds_read_b128 v[64:67], v13 offset:2048
    ds_read_b128 v[68:71], v14 offset:2048
    ds_read_b128 v[76:79], v12 offset:3072
    ds_read_b128 v[80:83], v13 offset:3072
    ds_read_b128 v[84:87], v14 offset:3072
    ds_read_b128 v[92:95], v12 offset:4096
    ds_read_b128 v[96:99], v13 offset:4096
    ds_read_b128 v[100:103], v14 offset:4096
    ds_read_b128 v[108:111], v12 offset:5120
    ds_read_b128 v[112:115], v13 offset:5120
    ds_read_b128 v[116:119], v14 offset:5120
    v_lshlrev_b32 v253, 16, v252
    v_lshlrev_b32 v255, 16, v254
    v_lshlrev_b32 v252, 16, v252
    v_lshlrev_b32 v254, 16, v254
    s_mul_i32 s94, s82, 98304
    s_add_u32 s94, s94, 4194304
    s_mul_i32 s91, s83, 12288
    s_add_u32 s91, s91, s94
    s_lshl_b32 s92, s81, 10
    s_add_u32 s91, s91, s92
    s_waitcnt lgkmcnt(15)
    v_pk_add_f32 v[24:25], v[24:25], v[28:29]
    v_pk_add_f32 v[26:27], v[26:27], v[30:31]
    v_pk_add_f32 v[32:33], v[32:33], v[36:37]
    v_pk_add_f32 v[34:35], v[34:35], v[38:39]
    v_pk_add_f32 v[24:25], v[24:25], v[32:33]
    v_pk_add_f32 v[26:27], v[26:27], v[34:35]
    v_cvt_pk_bf16_f32 v18, v24, v25
    v_cvt_pk_bf16_f32 v22, v26, v27
    v_lshlrev_b32 v16, 16, v18
    v_lshlrev_b32 v20, 16, v22
    v_and_b32 v17, 0xffff0000, v18
    v_and_b32 v21, 0xffff0000, v22
    v_pk_add_f32 v[16:17], v[16:17], v[252:253]
    v_pk_add_f32 v[20:21], v[20:21], v[252:253]
    v_cvt_pk_bf16_f32 v18, v16, v17
    v_cvt_pk_bf16_f32 v22, v20, v21
    v_lshlrev_b32 v24, 16, v240
    v_lshlrev_b32 v26, 16, v241
    v_and_b32 v25, 0xffff0000, v240
    v_and_b32 v27, 0xffff0000, v241
    v_lshlrev_b32 v16, 16, v18
    v_lshlrev_b32 v20, 16, v22
    v_and_b32 v17, 0xffff0000, v18
    v_and_b32 v21, 0xffff0000, v22
    v_pk_mul_f32 v[16:17], v[16:17], v[24:25]
    v_pk_mul_f32 v[20:21], v[20:21], v[26:27]
    v_cvt_pk_bf16_f32 v120, v16, v17
    v_cvt_pk_bf16_f32 v121, v20, v21
    s_waitcnt lgkmcnt(12)
    v_pk_add_f32 v[40:41], v[40:41], v[44:45]
    v_pk_add_f32 v[42:43], v[42:43], v[46:47]
    v_pk_add_f32 v[48:49], v[48:49], v[52:53]
    v_pk_add_f32 v[50:51], v[50:51], v[54:55]
    v_pk_add_f32 v[40:41], v[40:41], v[48:49]
    v_pk_add_f32 v[42:43], v[42:43], v[50:51]
    v_cvt_pk_bf16_f32 v18, v40, v41
    v_cvt_pk_bf16_f32 v22, v42, v43
    v_lshlrev_b32 v16, 16, v18
    v_lshlrev_b32 v20, 16, v22
    v_and_b32 v17, 0xffff0000, v18
    v_and_b32 v21, 0xffff0000, v22
    v_pk_add_f32 v[16:17], v[16:17], v[254:255]
    v_pk_add_f32 v[20:21], v[20:21], v[254:255]
    v_cvt_pk_bf16_f32 v18, v16, v17
    v_cvt_pk_bf16_f32 v22, v20, v21
    v_lshlrev_b32 v40, 16, v242
    v_lshlrev_b32 v42, 16, v243
    v_and_b32 v41, 0xffff0000, v242
    v_and_b32 v43, 0xffff0000, v243
    v_lshlrev_b32 v16, 16, v18
    v_lshlrev_b32 v20, 16, v22
    v_and_b32 v17, 0xffff0000, v18
    v_and_b32 v21, 0xffff0000, v22
    v_pk_mul_f32 v[16:17], v[16:17], v[40:41]
    v_pk_mul_f32 v[20:21], v[20:21], v[42:43]
    v_cvt_pk_bf16_f32 v122, v16, v17
    v_cvt_pk_bf16_f32 v123, v20, v21
    s_nop 0
    v_permlane32_swap_b32 v120, v122
    v_permlane32_swap_b32 v121, v123
    buffer_store_dwordx4 v[120:123], v5, s[68:71], s91 offen sc1
    s_add_u32 s91, s91, 4096
    s_waitcnt lgkmcnt(9)
    v_pk_add_f32 v[56:57], v[56:57], v[60:61]
    v_pk_add_f32 v[58:59], v[58:59], v[62:63]
    v_pk_add_f32 v[64:65], v[64:65], v[68:69]
    v_pk_add_f32 v[66:67], v[66:67], v[70:71]
    v_pk_add_f32 v[56:57], v[56:57], v[64:65]
    v_pk_add_f32 v[58:59], v[58:59], v[66:67]
    v_cvt_pk_bf16_f32 v18, v56, v57
    v_cvt_pk_bf16_f32 v22, v58, v59
    v_lshlrev_b32 v16, 16, v18
    v_lshlrev_b32 v20, 16, v22
    v_and_b32 v17, 0xffff0000, v18
    v_and_b32 v21, 0xffff0000, v22
    v_pk_add_f32 v[16:17], v[16:17], v[252:253]
    v_pk_add_f32 v[20:21], v[20:21], v[252:253]
    v_cvt_pk_bf16_f32 v18, v16, v17
    v_cvt_pk_bf16_f32 v22, v20, v21
    v_lshlrev_b32 v56, 16, v244
    v_lshlrev_b32 v58, 16, v245
    v_and_b32 v57, 0xffff0000, v244
    v_and_b32 v59, 0xffff0000, v245
    v_lshlrev_b32 v16, 16, v18
    v_lshlrev_b32 v20, 16, v22
    v_and_b32 v17, 0xffff0000, v18
    v_and_b32 v21, 0xffff0000, v22
    v_pk_mul_f32 v[16:17], v[16:17], v[56:57]
    v_pk_mul_f32 v[20:21], v[20:21], v[58:59]
    v_cvt_pk_bf16_f32 v124, v16, v17
    v_cvt_pk_bf16_f32 v125, v20, v21
    s_waitcnt lgkmcnt(6)
    v_pk_add_f32 v[72:73], v[72:73], v[76:77]
    v_pk_add_f32 v[74:75], v[74:75], v[78:79]
    v_pk_add_f32 v[80:81], v[80:81], v[84:85]
    v_pk_add_f32 v[82:83], v[82:83], v[86:87]
    v_pk_add_f32 v[72:73], v[72:73], v[80:81]
    v_pk_add_f32 v[74:75], v[74:75], v[82:83]
    v_cvt_pk_bf16_f32 v18, v72, v73
    v_cvt_pk_bf16_f32 v22, v74, v75
    v_lshlrev_b32 v16, 16, v18
    v_lshlrev_b32 v20, 16, v22
    v_and_b32 v17, 0xffff0000, v18
    v_and_b32 v21, 0xffff0000, v22
    v_pk_add_f32 v[16:17], v[16:17], v[254:255]
    v_pk_add_f32 v[20:21], v[20:21], v[254:255]
    v_cvt_pk_bf16_f32 v18, v16, v17
    v_cvt_pk_bf16_f32 v22, v20, v21
    v_lshlrev_b32 v72, 16, v246
    v_lshlrev_b32 v74, 16, v247
    v_and_b32 v73, 0xffff0000, v246
    v_and_b32 v75, 0xffff0000, v247
    v_lshlrev_b32 v16, 16, v18
    v_lshlrev_b32 v20, 16, v22
    v_and_b32 v17, 0xffff0000, v18
    v_and_b32 v21, 0xffff0000, v22
    v_pk_mul_f32 v[16:17], v[16:17], v[72:73]
    v_pk_mul_f32 v[20:21], v[20:21], v[74:75]
    v_cvt_pk_bf16_f32 v126, v16, v17
    v_cvt_pk_bf16_f32 v127, v20, v21
    s_nop 0
    v_permlane32_swap_b32 v124, v126
    v_permlane32_swap_b32 v125, v127
    buffer_store_dwordx4 v[124:127], v5, s[68:71], s91 offen sc1
    s_add_u32 s91, s91, 4096
    s_waitcnt lgkmcnt(3)
    v_pk_add_f32 v[88:89], v[88:89], v[92:93]
    v_pk_add_f32 v[90:91], v[90:91], v[94:95]
    v_pk_add_f32 v[96:97], v[96:97], v[100:101]
    v_pk_add_f32 v[98:99], v[98:99], v[102:103]
    v_pk_add_f32 v[88:89], v[88:89], v[96:97]
    v_pk_add_f32 v[90:91], v[90:91], v[98:99]
    v_cvt_pk_bf16_f32 v18, v88, v89
    v_cvt_pk_bf16_f32 v22, v90, v91
    v_lshlrev_b32 v16, 16, v18
    v_lshlrev_b32 v20, 16, v22
    v_and_b32 v17, 0xffff0000, v18
    v_and_b32 v21, 0xffff0000, v22
    v_pk_add_f32 v[16:17], v[16:17], v[252:253]
    v_pk_add_f32 v[20:21], v[20:21], v[252:253]
    v_cvt_pk_bf16_f32 v18, v16, v17
    v_cvt_pk_bf16_f32 v22, v20, v21
    v_lshlrev_b32 v88, 16, v248
    v_lshlrev_b32 v90, 16, v249
    v_and_b32 v89, 0xffff0000, v248
    v_and_b32 v91, 0xffff0000, v249
    v_lshlrev_b32 v16, 16, v18
    v_lshlrev_b32 v20, 16, v22
    v_and_b32 v17, 0xffff0000, v18
    v_and_b32 v21, 0xffff0000, v22
    v_pk_mul_f32 v[16:17], v[16:17], v[88:89]
    v_pk_mul_f32 v[20:21], v[20:21], v[90:91]
    v_cvt_pk_bf16_f32 v128, v16, v17
    v_cvt_pk_bf16_f32 v129, v20, v21
    s_waitcnt lgkmcnt(0)
    v_pk_add_f32 v[104:105], v[104:105], v[108:109]
    v_pk_add_f32 v[106:107], v[106:107], v[110:111]
    v_pk_add_f32 v[112:113], v[112:113], v[116:117]
    v_pk_add_f32 v[114:115], v[114:115], v[118:119]
    v_pk_add_f32 v[104:105], v[104:105], v[112:113]
    v_pk_add_f32 v[106:107], v[106:107], v[114:115]
    v_cvt_pk_bf16_f32 v18, v104, v105
    v_cvt_pk_bf16_f32 v22, v106, v107
    v_lshlrev_b32 v16, 16, v18
    v_lshlrev_b32 v20, 16, v22
    v_and_b32 v17, 0xffff0000, v18
    v_and_b32 v21, 0xffff0000, v22
    v_pk_add_f32 v[16:17], v[16:17], v[254:255]
    v_pk_add_f32 v[20:21], v[20:21], v[254:255]
    v_cvt_pk_bf16_f32 v18, v16, v17
    v_cvt_pk_bf16_f32 v22, v20, v21
    v_lshlrev_b32 v104, 16, v250
    v_lshlrev_b32 v106, 16, v251
    v_and_b32 v105, 0xffff0000, v250
    v_and_b32 v107, 0xffff0000, v251
    v_lshlrev_b32 v16, 16, v18
    v_lshlrev_b32 v20, 16, v22
    v_and_b32 v17, 0xffff0000, v18
    v_and_b32 v21, 0xffff0000, v22
    v_pk_mul_f32 v[16:17], v[16:17], v[104:105]
    v_pk_mul_f32 v[20:21], v[20:21], v[106:107]
    v_cvt_pk_bf16_f32 v130, v16, v17
    v_cvt_pk_bf16_f32 v131, v20, v21
    s_nop 0
    v_permlane32_swap_b32 v128, v130
    v_permlane32_swap_b32 v129, v131
    buffer_store_dwordx4 v[128:131], v5, s[68:71], s91 offen sc1
    s_barrier
    s_mul_i32 s4, s81, 15360
    s_add_u32 m0, s4, 0
    s_add_u32 s90, s76, 20480
    buffer_load_dwordx4 v5, s[68:71], s90 offen offset:0 sc1 lds
    buffer_load_dwordx4 v5, s[68:71], s90 offen offset:1024 sc1 lds
    buffer_load_dwordx4 v5, s[68:71], s90 offen offset:2048 sc1 lds
    buffer_load_dwordx4 v5, s[68:71], s90 offen offset:3072 sc1 lds
    s_add_u32 m0, s4, 4096
    s_add_u32 s90, s76, 24576
    buffer_load_dwordx4 v5, s[68:71], s90 offen offset:0 sc1 lds
    buffer_load_dwordx4 v5, s[68:71], s90 offen offset:1024 sc1 lds
    buffer_load_dwordx4 v5, s[68:71], s90 offen offset:2048 sc1 lds
    buffer_load_dwordx4 v5, s[68:71], s90 offen offset:3072 sc1 lds
    s_add_u32 m0, s4, 8192
    s_add_u32 s90, s76, 28672
    buffer_load_dwordx4 v5, s[68:71], s90 offen offset:0 sc1 lds
    buffer_load_dwordx4 v5, s[68:71], s90 offen offset:1024 sc1 lds
    s_nop 1
    v_and_b32 v16, 15, v1
    v_lshrrev_b32 v17, 4, v1
    v_and_b32 v7, 7, v1
    v_lshlrev_b32 v7, 2, v7
    s_lshl_b32 s91, s82, 7
    s_add_u32 s91, s91, 12288
    s_lshl_b32 s92, s81, 5
    s_add_u32 s92, s92, s91
    s_lshl_b32 s89, s82, 5
    s_add_u32 s89, s89, 20480
    v_add_u32 v8, s89, v7
    v_add_u32 v7, s92, v7
    s_lshl_b32 s92, s83, 4
    s_add_u32 s91, s91, s92
    s_lshl_b32 s92, s81, 2
    s_add_u32 s91, s91, s92
    s_mul_i32 s92, s83, 320
    s_add_u32 s92, s92, 16384
    v_lshlrev_b32 v9, 2, v1
    v_add_u32 v9, s92, v9
    v_lshlrev_b32 v19, 2, v16
    v_add_u32 v19, s92, v19
    v_add_u32 v19, 256, v19
    v_bfe_u32 v18, v1, 4, 1
    v_cmp_eq_u32 vcc, 1, v18
    s_nop 1
    v_cndmask_b32 v8, v8, v19, vcc
    s_lshl_b32 s89, s81, 7
    v_add_u32 v18, s89, v1
    s_lshl_b32 s89, s87, 6
    s_add_u32 s89, s89, 512
    v_add_u32 v19, s89, v1
    v_lshlrev_b32 v248, 4, v18
    v_lshlrev_b32 v249, 4, v19
    v_add_u32 v248, 61440, v248
    v_add_u32 v249, 61440, v249
    v_lshrrev_b32 v250, 3, v18
    v_and_b32 v18, 7, v18
    v_lshlrev_b32 v250, 12, v250
    v_lshl_add_u32 v250, v18, 4, v250
    v_lshrrev_b32 v251, 3, v19
    v_and_b32 v19, 7, v19
    v_lshlrev_b32 v251, 12, v251
    v_lshl_add_u32 v251, v19, 4, v251
    s_lshl_b32 s89, s82, 6
    s_lshl_b32 s90, s81, 4
    s_add_u32 s89, s89, s90
    v_add_u32 v18, s89, v16
    v_lshlrev_b32 v252, 3, v18
    v_add_u32 v252, 32768, v252
    v_mul_u32_u24 v18, 1280, v18
    s_mul_i32 s89, s83, 160
    v_add_u32 v18, s89, v18
    v_and_b32 v19, 1, v17
    v_lshl_add_u32 v10, v19, 5, v18
    v_lshrrev_b32 v19, 1, v17
    v_lshl_add_u32 v10, v19, 4, v10
    v_lshl_add_u32 v11, v17, 3, v18
    v_add_u32 v11, 128, v11
    v_lshl_add_u32 v18, v17, 6, v16
    v_lshlrev_b32 v18, 4, v18
    s_add_u32 s89, s81, 0
    s_and_b32 s89, s89, 3
    s_lshl_b32 s89, s89, 8
    v_add_u32 v2, s89, v18
    s_add_u32 s89, s81, 1
    s_and_b32 s89, s89, 3
    s_lshl_b32 s89, s89, 8
    v_add_u32 v3, s89, v18
    s_add_u32 s89, s81, 2
    s_and_b32 s89, s89, 3
    s_lshl_b32 s89, s89, 8
    v_add_u32 v4, s89, v18
    s_add_u32 s89, s81, 3
    s_and_b32 s89, s89, 3
    s_lshl_b32 s89, s89, 8
    v_add_u32 v6, s89, v18
    s_mul_i32 s89, s81, 24576
    s_add_u32 s94, s94, s89
    v_lshrrev_b32 v18, 2, v16
    v_lshl_add_u32 v18, v17, 2, v18
    v_lshlrev_b32 v18, 7, v18
    v_and_b32 v19, 3, v1
    v_lshl_add_u32 v18, v19, 3, v18
    s_lshl_b32 s89, s81, 5
    s_add_u32 s89, s89, 61440
    v_add_u32 v12, s89, v18
    s_waitcnt vmcnt(10)
    v_mov_b32 v16, s80
    s_mov_b64 s[12:13], exec
    s_mov_b64 exec, 1
    buffer_store_dword v16, off, s[68:71], s91 sc1
    s_mov_b64 exec, s[12:13]
    buffer_load_dword v20, v8, s[68:71], 0 offen sc1
    buffer_load_dword v21, v9, s[68:71], 0 offen sc1
    s_mov_b64 s[84:85], 0
    s_andn2_b32 s92, 15, s84
    s_cbranch_scc0 L_nb9_ok
    s_mov_b32 s93, 100000
L_nb9_spin:
    buffer_load_dword v253, v7, s[68:71], 0 offen sc1
    s_waitcnt vmcnt(0)
    v_cmp_eq_u32 s[84:85], s80, v253
    s_nop 3
    s_andn2_b32 s92, 15, s84
    s_cbranch_scc0 L_nb9_ok
    s_sleep 4
    s_sub_u32 s93, s93, 1
    s_cmp_lg_u32 s93, 0
    s_cbranch_scc1 L_nb9_spin
L_nb9_ok:
    s_add_u32 s89, s94, 0
    buffer_load_dwordx4 v[104:107], v2, s[68:71], s89 offen sc1
    buffer_load_dwordx4 v[108:111], v3, s[68:71], s89 offen sc1
    buffer_load_dwordx4 v[112:115], v4, s[68:71], s89 offen sc1
    buffer_load_dwordx4 v[116:119], v6, s[68:71], s89 offen sc1
    s_add_u32 s89, s94, 4096
    buffer_load_dwordx4 v[120:123], v2, s[68:71], s89 offen sc1
    buffer_load_dwordx4 v[124:127], v3, s[68:71], s89 offen sc1
    buffer_load_dwordx4 v[128:131], v4, s[68:71], s89 offen sc1
    buffer_load_dwordx4 v[132:135], v6, s[68:71], s89 offen sc1
    s_add_u32 s89, s94, 8192
    buffer_load_dwordx4 v[232:235], v2, s[68:71], s89 offen sc1
    buffer_load_dwordx4 v[236:239], v3, s[68:71], s89 offen sc1
    buffer_load_dwordx4 v[240:243], v4, s[68:71], s89 offen sc1
    buffer_load_dwordx4 v[244:247], v6, s[68:71], s89 offen sc1
    buffer_load_dword v253, v7, s[68:71], 0 offen sc1
    v_cmp_ne_u32 vcc, s80, v20
    v_cmp_ne_u32 s[84:85], s80, v21
    s_nop 3
    s_or_b64 vcc, vcc, s[84:85]
    s_cbranch_vccnz L_pa_late
    s_mul_i32 s91, s83, 327680
    s_lshl_b32 s92, s82, 7
    s_add_u32 s91, s91, s92
    s_add_u32 s91, s91, 10485760
    s_add_u32 s92, s91, 32768
    buffer_load_dwordx4 v[136:139], v250, s[68:71], s91 offen sc1
    buffer_load_dwordx4 v[140:143], v250, s[68:71], s92 offen sc1
    buffer_load_dwordx4 v[184:187], v251, s[68:71], s91 offen sc1
    buffer_load_dwordx2 v[188:189], v252, s[68:71], 0 offen sc1
    s_mov_b32 s10, 0
    s_branch L_pa_go
L_pa_late:
    buffer_load_dword v22, off, s[68:71], 0
    buffer_load_dword v22, off, s[68:71], 0
    buffer_load_dword v22, off, s[68:71], 0
    buffer_load_dword v22, off, s[68:71], 0
    s_mov_b32 s10, 1
L_pa_go:
    s_mul_i32 s91, s81, 15360
    v_add_u32 v13, s91, v5
    s_sub_u32 s91, s81, 1
    s_and_b32 s91, s91, 3
    s_mul_i32 s91, s91, 15360
    s_add_u32 s91, s91, 0
    v_add_u32 v14, s91, v5
    s_sub_u32 s91, s81, 2
    s_and_b32 s91, s91, 3
    s_mul_i32 s91, s91, 15360
    s_add_u32 s91, s91, 5120
    v_add_u32 v15, s91, v5
    s_sub_u32 s91, s81, 3
    s_and_b32 s91, s91, 3
    s_mul_i32 s91, s91, 15360
    s_add_u32 s91, s91, 10240
    v_add_u32 v0, s91, v5
    s_waitcnt vmcnt(13)
    v_mfma_f32_16x16x32_bf16 v[24:27], v[144:147], v[104:107], 0
    v_mfma_f32_16x16x32_bf16 v[28:31], v[148:151], v[104:107], 0
    v_mfma_f32_16x16x32_bf16 v[32:35], v[152:155], v[104:107], 0
    v_mfma_f32_16x16x32_bf16 v[36:39], v[156:159], v[104:107], 0
    v_mfma_f32_16x16x32_bf16 v[40:43], v[160:163], v[104:107], 0
    v_mfma_f32_16x16x32_bf16 v[44:47], v[144:147], v[108:111], 0
    v_mfma_f32_16x16x32_bf16 v[48:51], v[148:151], v[108:111], 0
    v_mfma_f32_16x16x32_bf16 v[52:55], v[152:155], v[108:111], 0
    v_mfma_f32_16x16x32_bf16 v[56:59], v[156:159], v[108:111], 0
    v_mfma_f32_16x16x32_bf16 v[60:63], v[160:163], v[108:111], 0
    v_mfma_f32_16x16x32_bf16 v[64:67], v[144:147], v[112:115], 0
    v_mfma_f32_16x16x32_bf16 v[68:71], v[148:151], v[112:115], 0
    v_mfma_f32_16x16x32_bf16 v[72:75], v[152:155], v[112:115], 0
    v_mfma_f32_16x16x32_bf16 v[76:79], v[156:159], v[112:115], 0
    v_mfma_f32_16x16x32_bf16 v[80:83], v[160:163], v[112:115], 0
    v_mfma_f32_16x16x32_bf16 v[84:87], v[144:147], v[116:119], 0
    v_mfma_f32_16x16x32_bf16 v[88:91], v[148:151], v[116:119], 0
    v_mfma_f32_16x16x32_bf16 v[92:95], v[152:155], v[116:119], 0
    v_mfma_f32_16x16x32_bf16 v[96:99], v[156:159], v[116:119], 0
    v_mfma_f32_16x16x32_bf16 v[100:103], v[160:163], v[116:119], 0
    s_waitcnt vmcnt(4)
    v_cmp_eq_u32 s[84:85], s80, v253
    s_nop 3
    s_andn2_b32 s92, 240, s84
    s_cbranch_scc0 L_nb10_ok
    s_mov_b32 s93, 100000
L_nb10_spin:
    buffer_load_dword v253, v7, s[68:71], 0 offen sc1
    s_waitcnt vmcnt(0)
    v_cmp_eq_u32 s[84:85], s80, v253
    s_nop 3
    s_andn2_b32 s92, 240, s84
    s_cbranch_scc0 L_nb10_ok
    s_sleep 4
    s_sub_u32 s93, s93, 1
    s_cmp_lg_u32 s93, 0
    s_cbranch_scc1 L_nb10_spin
L_nb10_ok:
    s_add_u32 s89, s94, 12288
    buffer_load_dwordx4 v[104:107], v2, s[68:71], s89 offen sc1
    buffer_load_dwordx4 v[108:111], v3, s[68:71], s89 offen sc1
    buffer_load_dwordx4 v[112:115], v4, s[68:71], s89 offen sc1
    buffer_load_dwordx4 v[116:119], v6, s[68:71], s89 offen sc1
    ds_read_b128 v[144:147], v13 offset:0
    ds_read_b128 v[148:151], v13 offset:1024
    ds_read_b128 v[152:155], v13 offset:2048
    ds_read_b128 v[156:159], v13 offset:3072
    ds_read_b128 v[160:163], v13 offset:4096
    s_waitcnt vmcnt(13)
    v_mfma_f32_16x16x32_bf16 v[24:27], v[164:167], v[120:123], v[24:27]
    v_mfma_f32_16x16x32_bf16 v[28:31], v[168:171], v[120:123], v[28:31]
    v_mfma_f32_16x16x32_bf16 v[32:35], v[172:175], v[120:123], v[32:35]
    v_mfma_f32_16x16x32_bf16 v[36:39], v[176:179], v[120:123], v[36:39]
    v_mfma_f32_16x16x32_bf16 v[40:43], v[180:183], v[120:123], v[40:43]
    v_mfma_f32_16x16x32_bf16 v[44:47], v[164:167], v[124:127], v[44:47]
    v_mfma_f32_16x16x32_bf16 v[48:51], v[168:171], v[124:127], v[48:51]
    v_mfma_f32_16x16x32_bf16 v[52:55], v[172:175], v[124:127], v[52:55]
    v_mfma_f32_16x16x32_bf16 v[56:59], v[176:179], v[124:127], v[56:59]
    v_mfma_f32_16x16x32_bf16 v[60:63], v[180:183], v[124:127], v[60:63]
    v_mfma_f32_16x16x32_bf16 v[64:67], v[164:167], v[128:131], v[64:67]
    v_mfma_f32_16x16x32_bf16 v[68:71], v[168:171], v[128:131], v[68:71]
    v_mfma_f32_16x16x32_bf16 v[72:75], v[172:175], v[128:131], v[72:75]
    v_mfma_f32_16x16x32_bf16 v[76:79], v[176:179], v[128:131], v[76:79]
    v_mfma_f32_16x16x32_bf16 v[80:83], v[180:183], v[128:131], v[80:83]
    v_mfma_f32_16x16x32_bf16 v[84:87], v[164:167], v[132:135], v[84:87]
    v_mfma_f32_16x16x32_bf16 v[88:91], v[168:171], v[132:135], v[88:91]
    v_mfma_f32_16x16x32_bf16 v[92:95], v[172:175], v[132:135], v[92:95]
    v_mfma_f32_16x16x32_bf16 v[96:99], v[176:179], v[132:135], v[96:99]
    v_mfma_f32_16x16x32_bf16 v[100:103], v[180:183], v[132:135], v[100:103]
    s_add_u32 s89, s94, 16384
    buffer_load_dwordx4 v[120:123], v2, s[68:71], s89 offen sc1
    buffer_load_dwordx4 v[124:127], v3, s[68:71], s89 offen sc1
    buffer_load_dwordx4 v[128:131], v4, s[68:71], s89 offen sc1
    buffer_load_dwordx4 v[132:135], v6, s[68:71], s89 offen sc1
    ds_read_b128 v[164:167], v13 offset:5120
    ds_read_b128 v[168:171], v13 offset:6144
    ds_read_b128 v[172:175], v13 offset:7168
    ds_read_b128 v[176:179], v13 offset:8192
    ds_read_b128 v[180:183], v13 offset:9216
    s_waitcnt vmcnt(13)
    v_mfma_f32_16x16x32_bf16 v[24:27], v[192:195], v[232:235], v[24:27]
    v_mfma_f32_16x16x32_bf16 v[28:31], v[196:199], v[232:235], v[28:31]
    v_mfma_f32_16x16x32_bf16 v[32:35], v[200:203], v[232:235], v[32:35]
    v_mfma_f32_16x16x32_bf16 v[36:39], v[204:207], v[232:235], v[36:39]
    v_mfma_f32_16x16x32_bf16 v[40:43], v[208:211], v[232:235], v[40:43]
    v_mfma_f32_16x16x32_bf16 v[44:47], v[192:195], v[236:239], v[44:47]
    v_mfma_f32_16x16x32_bf16 v[48:51], v[196:199], v[236:239], v[48:51]
    v_mfma_f32_16x16x32_bf16 v[52:55], v[200:203], v[236:239], v[52:55]
    v_mfma_f32_16x16x32_bf16 v[56:59], v[204:207], v[236:239], v[56:59]
    v_mfma_f32_16x16x32_bf16 v[60:63], v[208:211], v[236:239], v[60:63]
    v_mfma_f32_16x16x32_bf16 v[64:67], v[192:195], v[240:243], v[64:67]
    v_mfma_f32_16x16x32_bf16 v[68:71], v[196:199], v[240:243], v[68:71]
    v_mfma_f32_16x16x32_bf16 v[72:75], v[200:203], v[240:243], v[72:75]
    v_mfma_f32_16x16x32_bf16 v[76:79], v[204:207], v[240:243], v[76:79]
    v_mfma_f32_16x16x32_bf16 v[80:83], v[208:211], v[240:243], v[80:83]
    v_mfma_f32_16x16x32_bf16 v[84:87], v[192:195], v[244:247], v[84:87]
    v_mfma_f32_16x16x32_bf16 v[88:91], v[196:199], v[244:247], v[88:91]
    v_mfma_f32_16x16x32_bf16 v[92:95], v[200:203], v[244:247], v[92:95]
    v_mfma_f32_16x16x32_bf16 v[96:99], v[204:207], v[244:247], v[96:99]
    v_mfma_f32_16x16x32_bf16 v[100:103], v[208:211], v[244:247], v[100:103]
    s_add_u32 s89, s94, 20480
    buffer_load_dwordx4 v[232:235], v2, s[68:71], s89 offen sc1
    buffer_load_dwordx4 v[236:239], v3, s[68:71], s89 offen sc1
    buffer_load_dwordx4 v[240:243], v4, s[68:71], s89 offen sc1
    buffer_load_dwordx4 v[244:247], v6, s[68:71], s89 offen sc1
    s_waitcnt vmcnt(8)
    v_mfma_f32_16x16x32_bf16 v[24:27], v[212:215], v[104:107], v[24:27]
    v_mfma_f32_16x16x32_bf16 v[28:31], v[216:219], v[104:107], v[28:31]
    v_mfma_f32_16x16x32_bf16 v[32:35], v[220:223], v[104:107], v[32:35]
    v_mfma_f32_16x16x32_bf16 v[36:39], v[224:227], v[104:107], v[36:39]
    v_mfma_f32_16x16x32_bf16 v[40:43], v[228:231], v[104:107], v[40:43]
    v_mfma_f32_16x16x32_bf16 v[44:47], v[212:215], v[108:111], v[44:47]
    v_mfma_f32_16x16x32_bf16 v[48:51], v[216:219], v[108:111], v[48:51]
    v_mfma_f32_16x16x32_bf16 v[52:55], v[220:223], v[108:111], v[52:55]
    v_mfma_f32_16x16x32_bf16 v[56:59], v[224:227], v[108:111], v[56:59]
    v_mfma_f32_16x16x32_bf16 v[60:63], v[228:231], v[108:111], v[60:63]
    v_mfma_f32_16x16x32_bf16 v[64:67], v[212:215], v[112:115], v[64:67]
    v_mfma_f32_16x16x32_bf16 v[68:71], v[216:219], v[112:115], v[68:71]
    v_mfma_f32_16x16x32_bf16 v[72:75], v[220:223], v[112:115], v[72:75]
    v_mfma_f32_16x16x32_bf16 v[76:79], v[224:227], v[112:115], v[76:79]
    v_mfma_f32_16x16x32_bf16 v[80:83], v[228:231], v[112:115], v[80:83]
    v_mfma_f32_16x16x32_bf16 v[84:87], v[212:215], v[116:119], v[84:87]
    v_mfma_f32_16x16x32_bf16 v[88:91], v[216:219], v[116:119], v[88:91]
    v_mfma_f32_16x16x32_bf16 v[92:95], v[220:223], v[116:119], v[92:95]
    v_mfma_f32_16x16x32_bf16 v[96:99], v[224:227], v[116:119], v[96:99]
    v_mfma_f32_16x16x32_bf16 v[100:103], v[228:231], v[116:119], v[100:103]
    s_waitcnt vmcnt(4) lgkmcnt(5)
    v_mfma_f32_16x16x32_bf16 v[24:27], v[144:147], v[120:123], v[24:27]
    v_mfma_f32_16x16x32_bf16 v[28:31], v[148:151], v[120:123], v[28:31]
    v_mfma_f32_16x16x32_bf16 v[32:35], v[152:155], v[120:123], v[32:35]
    v_mfma_f32_16x16x32_bf16 v[36:39], v[156:159], v[120:123], v[36:39]
    v_mfma_f32_16x16x32_bf16 v[40:43], v[160:163], v[120:123], v[40:43]
    v_mfma_f32_16x16x32_bf16 v[44:47], v[144:147], v[124:127], v[44:47]
    v_mfma_f32_16x16x32_bf16 v[48:51], v[148:151], v[124:127], v[48:51]
    v_mfma_f32_16x16x32_bf16 v[52:55], v[152:155], v[124:127], v[52:55]
    v_mfma_f32_16x16x32_bf16 v[56:59], v[156:159], v[124:127], v[56:59]
    v_mfma_f32_16x16x32_bf16 v[60:63], v[160:163], v[124:127], v[60:63]
    v_mfma_f32_16x16x32_bf16 v[64:67], v[144:147], v[128:131], v[64:67]
    v_mfma_f32_16x16x32_bf16 v[68:71], v[148:151], v[128:131], v[68:71]
    v_mfma_f32_16x16x32_bf16 v[72:75], v[152:155], v[128:131], v[72:75]
    v_mfma_f32_16x16x32_bf16 v[76:79], v[156:159], v[128:131], v[76:79]
    v_mfma_f32_16x16x32_bf16 v[80:83], v[160:163], v[128:131], v[80:83]
    v_mfma_f32_16x16x32_bf16 v[84:87], v[144:147], v[132:135], v[84:87]
    v_mfma_f32_16x16x32_bf16 v[88:91], v[148:151], v[132:135], v[88:91]
    v_mfma_f32_16x16x32_bf16 v[92:95], v[152:155], v[132:135], v[92:95]
    v_mfma_f32_16x16x32_bf16 v[96:99], v[156:159], v[132:135], v[96:99]
    v_mfma_f32_16x16x32_bf16 v[100:103], v[160:163], v[132:135], v[100:103]
    s_waitcnt vmcnt(0) lgkmcnt(0)
    v_mfma_f32_16x16x32_bf16 v[44:47], v[164:167], v[236:239], v[44:47]
    v_mfma_f32_16x16x32_bf16 v[48:51], v[168:171], v[236:239], v[48:51]
    v_mfma_f32_16x16x32_bf16 v[52:55], v[172:175], v[236:239], v[52:55]
    v_mfma_f32_16x16x32_bf16 v[56:59], v[176:179], v[236:239], v[56:59]
    v_mfma_f32_16x16x32_bf16 v[60:63], v[180:183], v[236:239], v[60:63]
    v_mfma_f32_16x16x32_bf16 v[64:67], v[164:167], v[240:243], v[64:67]
    v_mfma_f32_16x16x32_bf16 v[68:71], v[168:171], v[240:243], v[68:71]
    v_mfma_f32_16x16x32_bf16 v[72:75], v[172:175], v[240:243], v[72:75]
    v_mfma_f32_16x16x32_bf16 v[76:79], v[176:179], v[240:243], v[76:79]
    v_mfma_f32_16x16x32_bf16 v[80:83], v[180:183], v[240:243], v[80:83]
    ds_write_b128 v13, v[44:47] offset:0
    ds_write_b128 v13, v[48:51] offset:1024
    ds_write_b128 v13, v[52:55] offset:2048
    ds_write_b128 v13, v[56:59] offset:3072
    ds_write_b128 v13, v[60:63] offset:4096
    v_mfma_f32_16x16x32_bf16 v[84:87], v[164:167], v[244:247], v[84:87]
    v_mfma_f32_16x16x32_bf16 v[88:91], v[168:171], v[244:247], v[88:91]
    v_mfma_f32_16x16x32_bf16 v[92:95], v[172:175], v[244:247], v[92:95]
    v_mfma_f32_16x16x32_bf16 v[96:99], v[176:179], v[244:247], v[96:99]
    v_mfma_f32_16x16x32_bf16 v[100:103], v[180:183], v[244:247], v[100:103]
    ds_write_b128 v13, v[64:67] offset:5120
    ds_write_b128 v13, v[68:71] offset:6144
    ds_write_b128 v13, v[72:75] offset:7168
    ds_write_b128 v13, v[76:79] offset:8192
    ds_write_b128 v13, v[80:83] offset:9216
    v_mfma_f32_16x16x32_bf16 v[24:27], v[164:167], v[232:235], v[24:27]
    v_mfma_f32_16x16x32_bf16 v[28:31], v[168:171], v[232:235], v[28:31]
    v_mfma_f32_16x16x32_bf16 v[32:35], v[172:175], v[232:235], v[32:35]
    v_mfma_f32_16x16x32_bf16 v[36:39], v[176:179], v[232:235], v[36:39]
    v_mfma_f32_16x16x32_bf16 v[40:43], v[180:183], v[232:235], v[40:43]
    ds_write_b128 v13, v[84:87] offset:10240
    ds_write_b128 v13, v[88:91] offset:11264
    ds_write_b128 v13, v[92:95] offset:12288
    ds_write_b128 v13, v[96:99] offset:13312
    ds_write_b128 v13, v[100:103] offset:14336
    s_cmp_eq_u32 s10, 0
    s_cbranch_scc1 L_pa_ok
    s_mov_b32 s93, 100000
L_pa_spin:
    buffer_load_dword v20, v8, s[68:71], 0 offen sc1
    buffer_load_dword v21, v9, s[68:71], 0 offen sc1
    s_waitcnt vmcnt(0)
    v_cmp_ne_u32 vcc, s80, v20
    v_cmp_ne_u32 s[84:85], s80, v21
    s_nop 3
    s_or_b64 vcc, vcc, s[84:85]
    s_cbranch_vccz L_pa_done
    s_sleep 2
    s_sub_u32 s93, s93, 1
    s_cmp_lg_u32 s93, 0
    s_cbranch_scc1 L_pa_spin
L_pa_done:
    s_mul_i32 s91, s83, 327680
    s_lshl_b32 s92, s82, 7
    s_add_u32 s91, s91, s92
    s_add_u32 s91, s91, 10485760
    s_add_u32 s92, s91, 32768
    buffer_load_dwordx4 v[136:139], v250, s[68:71], s91 offen sc1
    buffer_load_dwordx4 v[140:143], v250, s[68:71], s92 offen sc1
    buffer_load_dwordx4 v[184:187], v251, s[68:71], s91 offen sc1
    buffer_load_dwordx2 v[188:189], v252, s[68:71], 0 offen sc1
L_pa_ok:
    s_waitcnt vmcnt(0)
    v_mov_b32 v190, v189
    v_mov_b32 v191, v189
    v_mov_b32 v189, v188
    ds_write_b128 v248, v[136:139]
    ds_write_b128 v248, v[140:143] offset:1024
    ds_write_b128 v249, v[184:187]
    s_waitcnt lgkmcnt(0)
    s_barrier
    ds_read_b128 v[44:47], v14 offset:0
    ds_read_b128 v[64:67], v15 offset:0
    ds_read_b128 v[84:87], v0 offset:0
    ds_read_b64_tr_b16 v[104:105], v12 offset:0
    ds_read_b128 v[48:51], v14 offset:1024
    ds_read_b128 v[68:71], v15 offset:1024
    ds_read_b128 v[88:91], v0 offset:1024
    ds_read_b64_tr_b16 v[106:107], v12 offset:2048
    ds_read_b128 v[52:55], v14 offset:2048
    ds_read_b128 v[72:75], v15 offset:2048
    ds_read_b128 v[92:95], v0 offset:2048
    ds_read_b64_tr_b16 v[108:109], v12 offset:4096
    ds_read_b128 v[56:59], v14 offset:3072
    ds_read_b128 v[76:79], v15 offset:3072
    ds_read_b128 v[96:99], v0 offset:3072
    ds_read_b64_tr_b16 v[110:111], v12 offset:6144
    ds_read_b128 v[60:63], v14 offset:4096
    ds_read_b128 v[80:83], v15 offset:4096
    ds_read_b128 v[100:103], v0 offset:4096
    ds_read_b64_tr_b16 v[112:113], v12 offset:8192
    s_waitcnt lgkmcnt(15)
    v_pk_add_f32 v[24:25], v[24:25], v[44:45]
    v_pk_add_f32 v[26:27], v[26:27], v[46:47]
    v_pk_add_f32 v[64:65], v[64:65], v[84:85]
    v_pk_add_f32 v[66:67], v[66:67], v[86:87]
    v_pk_add_f32 v[24:25], v[24:25], v[64:65]
    v_pk_add_f32 v[26:27], v[26:27], v[66:67]
    v_cvt_pk_bf16_f32 v18, v24, v25
    v_cvt_pk_bf16_f32 v22, v26, v27
    v_lshlrev_b32 v16, 16, v104
    v_lshlrev_b32 v20, 16, v105
    v_and_b32 v17, 0xffff0000, v104
    v_and_b32 v21, 0xffff0000, v105
    v_lshlrev_b32 v24, 16, v18
    v_lshlrev_b32 v26, 16, v22
    v_and_b32 v25, 0xffff0000, v18
    v_and_b32 v27, 0xffff0000, v22
    v_pk_mul_f32 v[16:17], v[16:17], v[188:189]
    v_pk_mul_f32 v[20:21], v[20:21], v[188:189]
    v_pk_mul_f32 v[24:25], v[24:25], v[190:191]
    v_pk_mul_f32 v[26:27], v[26:27], v[190:191]
    v_cvt_pk_bf16_f32 v18, v16, v17
    v_cvt_pk_bf16_f32 v22, v20, v21
    v_cvt_pk_bf16_f32 v19, v24, v25
    v_cvt_pk_bf16_f32 v23, v26, v27
    v_lshlrev_b32 v16, 16, v18
    v_lshlrev_b32 v20, 16, v22
    v_and_b32 v17, 0xffff0000, v18
    v_and_b32 v21, 0xffff0000, v22
    v_lshlrev_b32 v24, 16, v19
    v_lshlrev_b32 v26, 16, v23
    v_and_b32 v25, 0xffff0000, v19
    v_and_b32 v27, 0xffff0000, v23
    v_pk_add_f32 v[16:17], v[16:17], v[24:25]
    v_pk_add_f32 v[20:21], v[20:21], v[26:27]
    v_cvt_pk_bf16_f32 v116, v16, v17
    v_cvt_pk_bf16_f32 v117, v20, v21
    s_waitcnt lgkmcnt(12)
    v_pk_add_f32 v[28:29], v[28:29], v[48:49]
    v_pk_add_f32 v[30:31], v[30:31], v[50:51]
    v_pk_add_f32 v[68:69], v[68:69], v[88:89]
    v_pk_add_f32 v[70:71], v[70:71], v[90:91]
    v_pk_add_f32 v[28:29], v[28:29], v[68:69]
    v_pk_add_f32 v[30:31], v[30:31], v[70:71]
    v_cvt_pk_bf16_f32 v18, v28, v29
    v_cvt_pk_bf16_f32 v22, v30, v31
    v_lshlrev_b32 v16, 16, v106
    v_lshlrev_b32 v20, 16, v107
    v_and_b32 v17, 0xffff0000, v106
    v_and_b32 v21, 0xffff0000, v107
    v_lshlrev_b32 v28, 16, v18
    v_lshlrev_b32 v30, 16, v22
    v_and_b32 v29, 0xffff0000, v18
    v_and_b32 v31, 0xffff0000, v22
    v_pk_mul_f32 v[16:17], v[16:17], v[188:189]
    v_pk_mul_f32 v[20:21], v[20:21], v[188:189]
    v_pk_mul_f32 v[28:29], v[28:29], v[190:191]
    v_pk_mul_f32 v[30:31], v[30:31], v[190:191]
    v_cvt_pk_bf16_f32 v18, v16, v17
    v_cvt_pk_bf16_f32 v22, v20, v21
    v_cvt_pk_bf16_f32 v19, v28, v29
    v_cvt_pk_bf16_f32 v23, v30, v31
    v_lshlrev_b32 v16, 16, v18
    v_lshlrev_b32 v20, 16, v22
    v_and_b32 v17, 0xffff0000, v18
    v_and_b32 v21, 0xffff0000, v22
    v_lshlrev_b32 v28, 16, v19
    v_lshlrev_b32 v30, 16, v23
    v_and_b32 v29, 0xffff0000, v19
    v_and_b32 v31, 0xffff0000, v23
    v_pk_add_f32 v[16:17], v[16:17], v[28:29]
    v_pk_add_f32 v[20:21], v[20:21], v[30:31]
    v_cvt_pk_bf16_f32 v118, v16, v17
    v_cvt_pk_bf16_f32 v119, v20, v21
    s_nop 0
    v_permlane16_swap_b32 v116, v118
    v_permlane16_swap_b32 v117, v119
    buffer_store_dwordx4 v[116:119], v10, s[72:75], 0 offen offset:0
    s_waitcnt lgkmcnt(8)
    v_pk_add_f32 v[32:33], v[32:33], v[52:53]
    v_pk_add_f32 v[34:35], v[34:35], v[54:55]
    v_pk_add_f32 v[72:73], v[72:73], v[92:93]
    v_pk_add_f32 v[74:75], v[74:75], v[94:95]
    v_pk_add_f32 v[32:33], v[32:33], v[72:73]
    v_pk_add_f32 v[34:35], v[34:35], v[74:75]
    v_cvt_pk_bf16_f32 v18, v32, v33
    v_cvt_pk_bf16_f32 v22, v34, v35
    v_lshlrev_b32 v16, 16, v108
    v_lshlrev_b32 v20, 16, v109
    v_and_b32 v17, 0xffff0000, v108
    v_and_b32 v21, 0xffff0000, v109
    v_lshlrev_b32 v32, 16, v18
    v_lshlrev_b32 v34, 16, v22
    v_and_b32 v33, 0xffff0000, v18
    v_and_b32 v35, 0xffff0000, v22
    v_pk_mul_f32 v[16:17], v[16:17], v[188:189]
    v_pk_mul_f32 v[20:21], v[20:21], v[188:189]
    v_pk_mul_f32 v[32:33], v[32:33], v[190:191]
    v_pk_mul_f32 v[34:35], v[34:35], v[190:191]
    v_cvt_pk_bf16_f32 v18, v16, v17
    v_cvt_pk_bf16_f32 v22, v20, v21
    v_cvt_pk_bf16_f32 v19, v32, v33
    v_cvt_pk_bf16_f32 v23, v34, v35
    v_lshlrev_b32 v16, 16, v18
    v_lshlrev_b32 v20, 16, v22
    v_and_b32 v17, 0xffff0000, v18
    v_and_b32 v21, 0xffff0000, v22
    v_lshlrev_b32 v32, 16, v19
    v_lshlrev_b32 v34, 16, v23
    v_and_b32 v33, 0xffff0000, v19
    v_and_b32 v35, 0xffff0000, v23
    v_pk_add_f32 v[16:17], v[16:17], v[32:33]
    v_pk_add_f32 v[20:21], v[20:21], v[34:35]
    v_cvt_pk_bf16_f32 v120, v16, v17
    v_cvt_pk_bf16_f32 v121, v20, v21
    s_waitcnt lgkmcnt(4)
    v_pk_add_f32 v[36:37], v[36:37], v[56:57]
    v_pk_add_f32 v[38:39], v[38:39], v[58:59]
    v_pk_add_f32 v[76:77], v[76:77], v[96:97]
    v_pk_add_f32 v[78:79], v[78:79], v[98:99]
    v_pk_add_f32 v[36:37], v[36:37], v[76:77]
    v_pk_add_f32 v[38:39], v[38:39], v[78:79]
    v_cvt_pk_bf16_f32 v18, v36, v37
    v_cvt_pk_bf16_f32 v22, v38, v39
    v_lshlrev_b32 v16, 16, v110
    v_lshlrev_b32 v20, 16, v111
    v_and_b32 v17, 0xffff0000, v110
    v_and_b32 v21, 0xffff0000, v111
    v_lshlrev_b32 v36, 16, v18
    v_lshlrev_b32 v38, 16, v22
    v_and_b32 v37, 0xffff0000, v18
    v_and_b32 v39, 0xffff0000, v22
    v_pk_mul_f32 v[16:17], v[16:17], v[188:189]
    v_pk_mul_f32 v[20:21], v[20:21], v[188:189]
    v_pk_mul_f32 v[36:37], v[36:37], v[190:191]
    v_pk_mul_f32 v[38:39], v[38:39], v[190:191]
    v_cvt_pk_bf16_f32 v18, v16, v17
    v_cvt_pk_bf16_f32 v22, v20, v21
    v_cvt_pk_bf16_f32 v19, v36, v37
    v_cvt_pk_bf16_f32 v23, v38, v39
    v_lshlrev_b32 v16, 16, v18
    v_lshlrev_b32 v20, 16, v22
    v_and_b32 v17, 0xffff0000, v18
    v_and_b32 v21, 0xffff0000, v22
    v_lshlrev_b32 v36, 16, v19
    v_lshlrev_b32 v38, 16, v23
    v_and_b32 v37, 0xffff0000, v19
    v_and_b32 v39, 0xffff0000, v23
    v_pk_add_f32 v[16:17], v[16:17], v[36:37]
    v_pk_add_f32 v[20:21], v[20:21], v[38:39]
    v_cvt_pk_bf16_f32 v122, v16, v17
    v_cvt_pk_bf16_f32 v123, v20, v21
    s_nop 0
    v_permlane16_swap_b32 v120, v122
    v_permlane16_swap_b32 v121, v123
    buffer_store_dwordx4 v[120:123], v10, s[72:75], 0 offen offset:64
    s_waitcnt lgkmcnt(0)
    v_pk_add_f32 v[40:41], v[40:41], v[60:61]
    v_pk_add_f32 v[42:43], v[42:43], v[62:63]
    v_pk_add_f32 v[80:81], v[80:81], v[100:101]
    v_pk_add_f32 v[82:83], v[82:83], v[102:103]
    v_pk_add_f32 v[40:41], v[40:41], v[80:81]
    v_pk_add_f32 v[42:43], v[42:43], v[82:83]
    v_cvt_pk_bf16_f32 v18, v40, v41
    v_cvt_pk_bf16_f32 v22, v42, v43
    v_lshlrev_b32 v16, 16, v112
    v_lshlrev_b32 v20, 16, v113
    v_and_b32 v17, 0xffff0000, v112
    v_and_b32 v21, 0xffff0000, v113
    v_lshlrev_b32 v40, 16, v18
    v_lshlrev_b32 v42, 16, v22
    v_and_b32 v41, 0xffff0000, v18
    v_and_b32 v43, 0xffff0000, v22
    v_pk_mul_f32 v[16:17], v[16:17], v[188:189]
    v_pk_mul_f32 v[20:21], v[20:21], v[188:189]
    v_pk_mul_f32 v[40:41], v[40:41], v[190:191]
    v_pk_mul_f32 v[42:43], v[42:43], v[190:191]
    v_cvt_pk_bf16_f32 v18, v16, v17
    v_cvt_pk_bf16_f32 v22, v20, v21
    v_cvt_pk_bf16_f32 v19, v40, v41
    v_cvt_pk_bf16_f32 v23, v42, v43
    v_lshlrev_b32 v16, 16, v18
    v_lshlrev_b32 v20, 16, v22
    v_and_b32 v17, 0xffff0000, v18
    v_and_b32 v21, 0xffff0000, v22
    v_lshlrev_b32 v40, 16, v19
    v_lshlrev_b32 v42, 16, v23
    v_and_b32 v41, 0xffff0000, v19
    v_and_b32 v43, 0xffff0000, v23
    v_pk_add_f32 v[16:17], v[16:17], v[40:41]
    v_pk_add_f32 v[20:21], v[20:21], v[42:43]
    v_cvt_pk_bf16_f32 v124, v16, v17
    v_cvt_pk_bf16_f32 v125, v20, v21
    buffer_store_dwordx2 v[124:125], v11, s[72:75], 0 offen
    s_endpgm
L_side:
    s_waitcnt lgkmcnt(0)
    s_mov_b32 s68, s50
    s_and_b32 s69, s51, 0xffff
    s_mov_b32 s70, 67108864
    s_mov_b32 s71, 0x00020000
    buffer_load_dword v127, off, s[68:71], 0 sc1
    s_cmp_eq_u32 s81, 3
    s_cbranch_scc1 L_gate
    s_lshl_b32 s82, s81, 8
    s_add_u32 s82, s82, s2
    s_sub_u32 s82, s82, 256
    s_cmp_lt_u32 s82, 640
    s_cbranch_scc1 L_chan
    s_cmp_eq_u32 s2, 511
    s_cbranch_scc1 L_keep
    s_cmp_lt_u32 s2, 480
    s_cbranch_scc1 L_retile
L_end:
    s_endpgm
L_chan:
    s_mul_i32 s83, s81, 26624
    s_mul_i32 s86, s82, 384
    v_lshlrev_b32 v2, 1, v1
    v_add_u32 v2, s86, v2
    s_lshl_b32 s86, s82, 1
    v_mov_b32 v3, s86
    global_load_ushort v28, v3, s[30:31]
    global_load_ushort v29, v3, s[32:33]
    global_load_ushort v10, v2, s[18:19] offset:0
    global_load_ushort v11, v2, s[20:21] offset:0
    global_load_ushort v12, v2, s[22:23] offset:0
    global_load_ushort v13, v2, s[24:25] offset:0
    global_load_ushort v14, v2, s[26:27] offset:0
    global_load_ushort v15, v2, s[28:29] offset:0
    global_load_ushort v16, v2, s[18:19] offset:128
    global_load_ushort v17, v2, s[20:21] offset:128
    global_load_ushort v18, v2, s[22:23] offset:128
    global_load_ushort v19, v2, s[24:25] offset:128
    global_load_ushort v20, v2, s[26:27] offset:128
    global_load_ushort v21, v2, s[28:29] offset:128
    global_load_ushort v22, v2, s[18:19] offset:256
    global_load_ushort v23, v2, s[20:21] offset:256
    global_load_ushort v24, v2, s[22:23] offset:256
    global_load_ushort v25, v2, s[24:25] offset:256
    global_load_ushort v26, v2, s[26:27] offset:256
    global_load_ushort v27, v2, s[28:29] offset:256
    v_and_b32 v6, 7, v1
    v_lshlrev_b32 v7, 7, v1
    v_add_u32 v7, s83, v7
    v_xor_b32 v8, 0, v6
    v_lshl_add_u32 v104, v8, 4, v7
    v_xor_b32 v8, 1, v6
    v_lshl_add_u32 v105, v8, 4, v7
    v_xor_b32 v8, 2, v6
    v_lshl_add_u32 v106, v8, 4, v7
    v_xor_b32 v8, 3, v6
    v_lshl_add_u32 v107, v8, 4, v7
    v_xor_b32 v8, 4, v6
    v_lshl_add_u32 v108, v8, 4, v7
    v_xor_b32 v8, 5, v6
    v_lshl_add_u32 v109, v8, 4, v7
    v_xor_b32 v8, 6, v6
    v_lshl_add_u32 v110, v8, 4, v7
    v_xor_b32 v8, 7, v6
    v_lshl_add_u32 v111, v8, 4, v7
    v_lshrrev_b32 v6, 5, v1
    v_bfe_u32 v7, v1, 3, 1
    v_lshl_add_u32 v6, v6, 2, v7
    v_bfe_u32 v7, v1, 2, 1
    v_lshlrev_b32 v7, 2, v7
    v_bfe_u32 v8, v1, 4, 1
    v_lshl_add_u32 v7, v8, 1, v7
    v_bfe_u32 v8, v1, 1, 1
    v_add_u32 v7, v7, v8
    v_and_b32 v9, 1, v1
    v_lshlrev_b32 v9, 3, v9
    v_add_u32 v9, s83, v9
    v_xor_b32 v8, v7, v6
    v_lshl_add_u32 v4, v8, 4, v9
    v_lshl_add_u32 v4, v6, 7, v4
    v_add_u32 v6, 2, v6
    v_xor_b32 v8, v7, v6
    v_lshl_add_u32 v5, v8, 4, v9
    v_lshl_add_u32 v5, v6, 7, v5
    v_and_b32 v6, 31, v1
    v_lshrrev_b32 v7, 5, v1
    s_waitcnt vmcnt(18)
    v_readfirstlane_b32 s80, v127
    s_nop 3
    s_add_u32 s80, s80, 1
    v_lshlrev_b32 v28, 16, v28
    v_lshlrev_b32 v29, 16, v29
    v_mul_f32 v8, 0x3fb8a000, v28
    v_rndne_f32 v9, v8
    v_sub_f32 v8, v8, v9
    v_fmac_f32 v8, 0x39a3b296, v28
    v_exp_f32 v8, v8
    v_cvt_i32_f32 v9, v9
    v_ldexp_f32 v8, v8, v9
    v_cvt_pk_bf16_f32 v8, v8, v8
    v_lshlrev_b32 v28, 16, v8
    s_waitcnt vmcnt(0)
    v_lshlrev_b32 v10, 16, v10
    v_lshlrev_b32 v11, 16, v11
    v_lshlrev_b32 v12, 16, v12
    v_lshlrev_b32 v13, 16, v13
    v_lshlrev_b32 v14, 16, v14
    v_lshlrev_b32 v15, 16, v15
    v_lshlrev_b32 v16, 16, v16
    v_lshlrev_b32 v17, 16, v17
    v_lshlrev_b32 v18, 16, v18
    v_lshlrev_b32 v19, 16, v19
    v_lshlrev_b32 v20, 16, v20
    v_lshlrev_b32 v21, 16, v21
    v_lshlrev_b32 v22, 16, v22
    v_lshlrev_b32 v23, 16, v23
    v_lshlrev_b32 v24, 16, v24
    v_lshlrev_b32 v25, 16, v25
    v_lshlrev_b32 v26, 16, v26
    v_lshlrev_b32 v27, 16, v27
    v_mul_f32 v10, v28, v10
    v_mul_f32 v11, v28, v11
    v_mul_f32 v12, v28, v12
    v_mul_f32 v13, v28, v13
    v_mul_f32 v38, 0x3fb8aa3b, v10
    v_mul_f32 v39, 0x3e22f983, v11
    v_pk_mul_f32 v[8:9], v[14:15], v[12:13] op_sel:[0,0] op_sel_hi:[0,1]
    v_pk_fma_f32 v[32:33], v[14:15], v[12:13], v[8:9] op_sel:[1,1,0] op_sel_hi:[1,0,1] neg_lo:[1,0,0]
    v_mul_f32 v16, v28, v16
    v_mul_f32 v17, v28, v17
    v_mul_f32 v18, v28, v18
    v_mul_f32 v19, v28, v19
    v_mul_f32 v40, 0x3fb8aa3b, v16
    v_mul_f32 v41, 0x3e22f983, v17
    v_pk_mul_f32 v[8:9], v[20:21], v[18:19] op_sel:[0,0] op_sel_hi:[0,1]
    v_pk_fma_f32 v[34:35], v[20:21], v[18:19], v[8:9] op_sel:[1,1,0] op_sel_hi:[1,0,1] neg_lo:[1,0,0]
    v_mul_f32 v22, v28, v22
    v_mul_f32 v23, v28, v23
    v_mul_f32 v24, v28, v24
    v_mul_f32 v25, v28, v25
    v_mul_f32 v42, 0x3fb8aa3b, v22
    v_mul_f32 v43, 0x3e22f983, v23
    v_pk_mul_f32 v[8:9], v[26:27], v[24:25] op_sel:[0,0] op_sel_hi:[0,1]
    v_pk_fma_f32 v[36:37], v[26:27], v[24:25], v[8:9] op_sel:[1,1,0] op_sel_hi:[1,0,1] neg_lo:[1,0,0]
    v_max3_f32 v8, abs(v32), abs(v33), abs(v34)
    v_max3_f32 v8, v8, abs(v35), abs(v36)
    v_max_f32 v8, v8, abs(v37)
    s_nop 1
    v_max_f32_dpp v8, v8, v8 row_ror:8 row_mask:0xf bank_mask:0xf
    s_nop 1
    v_max_f32_dpp v8, v8, v8 row_ror:4 row_mask:0xf bank_mask:0xf
    s_nop 1
    v_max_f32_dpp v8, v8, v8 row_ror:2 row_mask:0xf bank_mask:0xf
    s_nop 1
    v_max_f32_dpp v8, v8, v8 row_ror:1 row_mask:0xf bank_mask:0xf
    s_nop 0
    v_readlane_b32 s86, v8, 0
    v_readlane_b32 s87, v8, 16
    s_nop 3
    s_max_u32 s86, s86, s87
    v_readlane_b32 s87, v8, 32
    s_nop 3
    s_max_u32 s86, s86, s87
    v_readlane_b32 s87, v8, 48
    s_nop 3
    s_max_u32 s86, s86, s87
    s_lshr_b32 s86, s86, 23
    s_min_u32 s86, s86, 252
    s_add_u32 s88, s86, 1
    s_lshl_b32 s88, s88, 23
    s_sub_u32 s86, 253, s86
    s_lshl_b32 s86, s86, 23
    v_mul_f32 v32, s86, v32
    v_mul_f32 v33, s86, v33
    v_mul_f32 v34, s86, v34
    v_mul_f32 v35, s86, v35
    v_mul_f32 v36, s86, v36
    v_mul_f32 v37, s86, v37
    v_mov_b32 v72, 0
    v_mov_b32 v73, 0
    v_mov_b32 v74, 0
    v_mov_b32 v75, 0
    v_mov_b32 v76, 0
    v_mov_b32 v77, 0
    v_mov_b32 v78, 0
    v_mov_b32 v79, 0
    v_mov_b32 v80, 0
    v_mov_b32 v81, 0
    v_mov_b32 v82, 0
    v_mov_b32 v83, 0
    v_mov_b32 v84, 0
    v_mov_b32 v85, 0
    v_mov_b32 v86, 0
    v_mov_b32 v87, 0
    s_lshr_b32 s90, s82, 6
    s_lshl_b32 s90, s90, 7
    s_add_u32 s90, s90, 8192
    v_lshlrev_b32 v248, 2, v6
    v_lshlrev_b32 v249, 4, v1
    s_lshl_b32 s92, s82, 12
    s_add_u32 s92, s92, 7340032
    s_mov_b32 s91, 1
    s_mov_b32 s89, 3
L_kg_chunk:
    v_mul_f32 v8, 0x41000000, v38
    v_mul_f32 v9, 0x41000000, v39
    v_exp_f32 v8, v8
    v_fract_f32 v9, v9
    v_cos_f32 v46, v9
    v_sin_f32 v47, v9
    s_nop 0
    v_pk_mul_f32 v[46:47], v[46:47], v[8:9] op_sel:[0,0] op_sel_hi:[1,0]
    v_exp_f32 v8, v38
    v_fract_f32 v9, v39
    v_cos_f32 v44, v9
    v_sin_f32 v45, v9
    s_nop 0
    v_pk_mul_f32 v[44:45], v[44:45], v[8:9] op_sel:[0,0] op_sel_hi:[1,0]
    v_mul_f32 v8, 0x43800000, v38
    v_mul_f32 v9, 0x43800000, v39
    v_exp_f32 v8, v8
    v_fract_f32 v9, v9
    v_cos_f32 v48, v9
    v_sin_f32 v49, v9
    s_nop 0
    v_pk_mul_f32 v[48:49], v[48:49], v[8:9] op_sel:[0,0] op_sel_hi:[1,0]
    v_mov_b32 v54, 1.0
    v_mov_b32 v55, 0
    v_cvt_pk_f16_f32 v200, v54, v46
    v_cvt_pk_f16_f32 v216, -v55, -v47
    v_pk_mul_f32 v[8:9], v[46:47], v[46:47] op_sel:[0,0] op_sel_hi:[0,1]
    v_pk_fma_f32 v[50:51], v[46:47], v[46:47], v[8:9] op_sel:[1,1,0] op_sel_hi:[1,0,1] neg_lo:[1,0,0]
    v_pk_mul_f32 v[8:9], v[50:51], v[46:47] op_sel:[0,0] op_sel_hi:[0,1]
    v_pk_fma_f32 v[52:53], v[50:51], v[46:47], v[8:9] op_sel:[1,1,0] op_sel_hi:[1,0,1] neg_lo:[1,0,0]
    v_cvt_pk_f16_f32 v201, v50, v52
    v_cvt_pk_f16_f32 v217, -v51, -v53
    v_pk_mul_f32 v[8:9], v[52:53], v[46:47] op_sel:[0,0] op_sel_hi:[0,1]
    v_pk_fma_f32 v[50:51], v[52:53], v[46:47], v[8:9] op_sel:[1,1,0] op_sel_hi:[1,0,1] neg_lo:[1,0,0]
    v_pk_mul_f32 v[8:9], v[50:51], v[46:47] op_sel:[0,0] op_sel_hi:[0,1]
    v_pk_fma_f32 v[52:53], v[50:51], v[46:47], v[8:9] op_sel:[1,1,0] op_sel_hi:[1,0,1] neg_lo:[1,0,0]
    v_cvt_pk_f16_f32 v202, v50, v52
    v_cvt_pk_f16_f32 v218, -v51, -v53
    v_pk_mul_f32 v[8:9], v[52:53], v[46:47] op_sel:[0,0] op_sel_hi:[0,1]
    v_pk_fma_f32 v[50:51], v[52:53], v[46:47], v[8:9] op_sel:[1,1,0] op_sel_hi:[1,0,1] neg_lo:[1,0,0]
    v_pk_mul_f32 v[8:9], v[50:51], v[46:47] op_sel:[0,0] op_sel_hi:[0,1]
    v_pk_fma_f32 v[52:53], v[50:51], v[46:47], v[8:9] op_sel:[1,1,0] op_sel_hi:[1,0,1] neg_lo:[1,0,0]
    v_cvt_pk_f16_f32 v203, v50, v52
    v_cvt_pk_f16_f32 v219, -v51, -v53
    ds_write_b128 v104, v[200:203] offset:8192
    ds_write_b128 v108, v[216:219] offset:8192
    v_pk_mul_f32 v[8:9], v[52:53], v[46:47] op_sel:[0,0] op_sel_hi:[0,1]
    v_pk_fma_f32 v[50:51], v[52:53], v[46:47], v[8:9] op_sel:[1,1,0] op_sel_hi:[1,0,1] neg_lo:[1,0,0]
    v_pk_mul_f32 v[8:9], v[50:51], v[46:47] op_sel:[0,0] op_sel_hi:[0,1]
    v_pk_fma_f32 v[52:53], v[50:51], v[46:47], v[8:9] op_sel:[1,1,0] op_sel_hi:[1,0,1] neg_lo:[1,0,0]
    v_cvt_pk_f16_f32 v204, v50, v52
    v_cvt_pk_f16_f32 v220, -v51, -v53
    v_pk_mul_f32 v[8:9], v[52:53], v[46:47] op_sel:[0,0] op_sel_hi:[0,1]
    v_pk_fma_f32 v[50:51], v[52:53], v[46:47], v[8:9] op_sel:[1,1,0] op_sel_hi:[1,0,1] neg_lo:[1,0,0]
    v_pk_mul_f32 v[8:9], v[50:51], v[46:47] op_sel:[0,0] op_sel_hi:[0,1]
    v_pk_fma_f32 v[52:53], v[50:51], v[46:47], v[8:9] op_sel:[1,1,0] op_sel_hi:[1,0,1] neg_lo:[1,0,0]
    v_cvt_pk_f16_f32 v205, v50, v52
    v_cvt_pk_f16_f32 v221, -v51, -v53
    v_pk_mul_f32 v[8:9], v[52:53], v[46:47] op_sel:[0,0] op_sel_hi:[0,1]
    v_pk_fma_f32 v[50:51], v[52:53], v[46:47], v[8:9] op_sel:[1,1,0] op_sel_hi:[1,0,1] neg_lo:[1,0,0]
    v_pk_mul_f32 v[8:9], v[50:51], v[46:47] op_sel:[0,0] op_sel_hi:[0,1]
    v_pk_fma_f32 v[52:53], v[50:51], v[46:47], v[8:9] op_sel:[1,1,0] op_sel_hi:[1,0,1] neg_lo:[1,0,0]
    v_cvt_pk_f16_f32 v206, v50, v52
    v_cvt_pk_f16_f32 v222, -v51, -v53
    v_pk_mul_f32 v[8:9], v[52:53], v[46:47] op_sel:[0,0] op_sel_hi:[0,1]
    v_pk_fma_f32 v[50:51], v[52:53], v[46:47], v[8:9] op_sel:[1,1,0] op_sel_hi:[1,0,1] neg_lo:[1,0,0]
    v_pk_mul_f32 v[8:9], v[50:51], v[46:47] op_sel:[0,0] op_sel_hi:[0,1]
    v_pk_fma_f32 v[52:53], v[50:51], v[46:47], v[8:9] op_sel:[1,1,0] op_sel_hi:[1,0,1] neg_lo:[1,0,0]
    v_cvt_pk_f16_f32 v207, v50, v52
    v_cvt_pk_f16_f32 v223, -v51, -v53
    ds_write_b128 v105, v[204:207] offset:8192
    ds_write_b128 v109, v[220:223] offset:8192
    v_pk_mul_f32 v[8:9], v[52:53], v[46:47] op_sel:[0,0] op_sel_hi:[0,1]
    v_pk_fma_f32 v[50:51], v[52:53], v[46:47], v[8:9] op_sel:[1,1,0] op_sel_hi:[1,0,1] neg_lo:[1,0,0]
    v_pk_mul_f32 v[8:9], v[50:51], v[46:47] op_sel:[0,0] op_sel_hi:[0,1]
    v_pk_fma_f32 v[52:53], v[50:51], v[46:47], v[8:9] op_sel:[1,1,0] op_sel_hi:[1,0,1] neg_lo:[1,0,0]
    v_cvt_pk_f16_f32 v208, v50, v52
    v_cvt_pk_f16_f32 v224, -v51, -v53
    v_pk_mul_f32 v[8:9], v[52:53], v[46:47] op_sel:[0,0] op_sel_hi:[0,1]
    v_pk_fma_f32 v[50:51], v[52:53], v[46:47], v[8:9] op_sel:[1,1,0] op_sel_hi:[1,0,1] neg_lo:[1,0,0]
    v_pk_mul_f32 v[8:9], v[50:51], v[46:47] op_sel:[0,0] op_sel_hi:[0,1]
    v_pk_fma_f32 v[52:53], v[50:51], v[46:47], v[8:9] op_sel:[1,1,0] op_sel_hi:[1,0,1] neg_lo:[1,0,0]
    v_cvt_pk_f16_f32 v209, v50, v52
    v_cvt_pk_f16_f32 v225, -v51, -v53
    v_pk_mul_f32 v[8:9], v[52:53], v[46:47] op_sel:[0,0] op_sel_hi:[0,1]
    v_pk_fma_f32 v[50:51], v[52:53], v[46:47], v[8:9] op_sel:[1,1,0] op_sel_hi:[1,0,1] neg_lo:[1,0,0]
    v_pk_mul_f32 v[8:9], v[50:51], v[46:47] op_sel:[0,0] op_sel_hi:[0,1]
    v_pk_fma_f32 v[52:53], v[50:51], v[46:47], v[8:9] op_sel:[1,1,0] op_sel_hi:[1,0,1] neg_lo:[1,0,0]
    v_cvt_pk_f16_f32 v210, v50, v52
    v_cvt_pk_f16_f32 v226, -v51, -v53
    v_pk_mul_f32 v[8:9], v[52:53], v[46:47] op_sel:[0,0] op_sel_hi:[0,1]
    v_pk_fma_f32 v[50:51], v[52:53], v[46:47], v[8:9] op_sel:[1,1,0] op_sel_hi:[1,0,1] neg_lo:[1,0,0]
    v_pk_mul_f32 v[8:9], v[50:51], v[46:47] op_sel:[0,0] op_sel_hi:[0,1]
    v_pk_fma_f32 v[52:53], v[50:51], v[46:47], v[8:9] op_sel:[1,1,0] op_sel_hi:[1,0,1] neg_lo:[1,0,0]
    v_cvt_pk_f16_f32 v211, v50, v52
    v_cvt_pk_f16_f32 v227, -v51, -v53
    ds_write_b128 v106, v[208:211] offset:8192
    ds_write_b128 v110, v[224:227] offset:8192
    v_pk_mul_f32 v[8:9], v[52:53], v[46:47] op_sel:[0,0] op_sel_hi:[0,1]
    v_pk_fma_f32 v[50:51], v[52:53], v[46:47], v[8:9] op_sel:[1,1,0] op_sel_hi:[1,0,1] neg_lo:[1,0,0]
    v_pk_mul_f32 v[8:9], v[50:51], v[46:47] op_sel:[0,0] op_sel_hi:[0,1]
    v_pk_fma_f32 v[52:53], v[50:51], v[46:47], v[8:9] op_sel:[1,1,0] op_sel_hi:[1,0,1] neg_lo:[1,0,0]
    v_cvt_pk_f16_f32 v212, v50, v52
    v_cvt_pk_f16_f32 v228, -v51, -v53
    v_pk_mul_f32 v[8:9], v[52:53], v[46:47] op_sel:[0,0] op_sel_hi:[0,1]
    v_pk_fma_f32 v[50:51], v[52:53], v[46:47], v[8:9] op_sel:[1,1,0] op_sel_hi:[1,0,1] neg_lo:[1,0,0]
    v_pk_mul_f32 v[8:9], v[50:51], v[46:47] op_sel:[0,0] op_sel_hi:[0,1]
    v_pk_fma_f32 v[52:53], v[50:51], v[46:47], v[8:9] op_sel:[1,1,0] op_sel_hi:[1,0,1] neg_lo:[1,0,0]
    v_cvt_pk_f16_f32 v213, v50, v52
    v_cvt_pk_f16_f32 v229, -v51, -v53
    v_pk_mul_f32 v[8:9], v[52:53], v[46:47] op_sel:[0,0] op_sel_hi:[0,1]
    v_pk_fma_f32 v[50:51], v[52:53], v[46:47], v[8:9] op_sel:[1,1,0] op_sel_hi:[1,0,1] neg_lo:[1,0,0]
    v_pk_mul_f32 v[8:9], v[50:51], v[46:47] op_sel:[0,0] op_sel_hi:[0,1]
    v_pk_fma_f32 v[52:53], v[50:51], v[46:47], v[8:9] op_sel:[1,1,0] op_sel_hi:[1,0,1] neg_lo:[1,0,0]
    v_cvt_pk_f16_f32 v214, v50, v52
    v_cvt_pk_f16_f32 v230, -v51, -v53
    v_pk_mul_f32 v[8:9], v[52:53], v[46:47] op_sel:[0,0] op_sel_hi:[0,1]
    v_pk_fma_f32 v[50:51], v[52:53], v[46:47], v[8:9] op_sel:[1,1,0] op_sel_hi:[1,0,1] neg_lo:[1,0,0]
    v_pk_mul_f32 v[8:9], v[50:51], v[46:47] op_sel:[0,0] op_sel_hi:[0,1]
    v_pk_fma_f32 v[52:53], v[50:51], v[46:47], v[8:9] op_sel:[1,1,0] op_sel_hi:[1,0,1] neg_lo:[1,0,0]
    v_cvt_pk_f16_f32 v215, v50, v52
    v_cvt_pk_f16_f32 v231, -v51, -v53
    ds_write_b128 v107, v[212:215] offset:8192
    ds_write_b128 v111, v[228:231] offset:8192
    v_pk_mul_f32 v[8:9], v[32:33], v[44:45] op_sel:[0,0] op_sel_hi:[0,1]
    v_pk_fma_f32 v[112:113], v[32:33], v[44:45], v[8:9] op_sel:[1,1,0] op_sel_hi:[1,0,1] neg_lo:[1,0,0]
    v_cvt_pk_f16_f32 v168, v32, v112
    v_cvt_pk_f16_f32 v184, v33, v113
    v_pk_mul_f32 v[8:9], v[112:113], v[44:45] op_sel:[0,0] op_sel_hi:[0,1]
    v_pk_fma_f32 v[114:115], v[112:113], v[44:45], v[8:9] op_sel:[1,1,0] op_sel_hi:[1,0,1] neg_lo:[1,0,0]
    v_pk_mul_f32 v[8:9], v[114:115], v[44:45] op_sel:[0,0] op_sel_hi:[0,1]
    v_pk_fma_f32 v[116:117], v[114:115], v[44:45], v[8:9] op_sel:[1,1,0] op_sel_hi:[1,0,1] neg_lo:[1,0,0]
    v_cvt_pk_f16_f32 v169, v114, v116
    v_cvt_pk_f16_f32 v185, v115, v117
    v_pk_mul_f32 v[8:9], v[116:117], v[44:45] op_sel:[0,0] op_sel_hi:[0,1]
    v_pk_fma_f32 v[118:119], v[116:117], v[44:45], v[8:9] op_sel:[1,1,0] op_sel_hi:[1,0,1] neg_lo:[1,0,0]
    v_pk_mul_f32 v[8:9], v[118:119], v[44:45] op_sel:[0,0] op_sel_hi:[0,1]
    v_pk_fma_f32 v[120:121], v[118:119], v[44:45], v[8:9] op_sel:[1,1,0] op_sel_hi:[1,0,1] neg_lo:[1,0,0]
    v_cvt_pk_f16_f32 v172, v118, v120
    v_cvt_pk_f16_f32 v188, v119, v121
    v_pk_mul_f32 v[8:9], v[120:121], v[44:45] op_sel:[0,0] op_sel_hi:[0,1]
    v_pk_fma_f32 v[122:123], v[120:121], v[44:45], v[8:9] op_sel:[1,1,0] op_sel_hi:[1,0,1] neg_lo:[1,0,0]
    v_pk_mul_f32 v[8:9], v[122:123], v[44:45] op_sel:[0,0] op_sel_hi:[0,1]
    v_pk_fma_f32 v[124:125], v[122:123], v[44:45], v[8:9] op_sel:[1,1,0] op_sel_hi:[1,0,1] neg_lo:[1,0,0]
    v_cvt_pk_f16_f32 v173, v122, v124
    v_cvt_pk_f16_f32 v189, v123, v125
    v_pk_mul_f32 v[8:9], v[124:125], v[44:45] op_sel:[0,0] op_sel_hi:[0,1]
    v_pk_fma_f32 v[126:127], v[124:125], v[44:45], v[8:9] op_sel:[1,1,0] op_sel_hi:[1,0,1] neg_lo:[1,0,0]
    v_pk_mul_f32 v[8:9], v[32:33], v[48:49] op_sel:[0,0] op_sel_hi:[0,1]
    v_pk_fma_f32 v[128:129], v[32:33], v[48:49], v[8:9] op_sel:[1,1,0] op_sel_hi:[1,0,1] neg_lo:[1,0,0]
    v_cvt_pk_f16_f32 v170, v128, v128
    v_cvt_pk_f16_f32 v186, v129, v129
    v_pk_mul_f32 v[8:9], v[114:115], v[48:49] op_sel:[0,0] op_sel_hi:[0,1]
    v_pk_fma_f32 v[130:131], v[114:115], v[48:49], v[8:9] op_sel:[1,1,0] op_sel_hi:[1,0,1] neg_lo:[1,0,0]
    v_pk_mul_f32 v[8:9], v[118:119], v[48:49] op_sel:[0,0] op_sel_hi:[0,1]
    v_pk_fma_f32 v[132:133], v[118:119], v[48:49], v[8:9] op_sel:[1,1,0] op_sel_hi:[1,0,1] neg_lo:[1,0,0]
    v_cvt_pk_f16_f32 v171, v130, v132
    v_cvt_pk_f16_f32 v187, v131, v133
    ds_write_b128 v104, v[168:171] offset:0
    ds_write_b128 v108, v[184:187] offset:0
    v_cvt_pk_f16_f32 v174, v132, v132
    v_cvt_pk_f16_f32 v190, v133, v133
    v_pk_mul_f32 v[8:9], v[122:123], v[48:49] op_sel:[0,0] op_sel_hi:[0,1]
    v_pk_fma_f32 v[134:135], v[122:123], v[48:49], v[8:9] op_sel:[1,1,0] op_sel_hi:[1,0,1] neg_lo:[1,0,0]
    v_pk_mul_f32 v[8:9], v[126:127], v[48:49] op_sel:[0,0] op_sel_hi:[0,1]
    v_pk_fma_f32 v[136:137], v[126:127], v[48:49], v[8:9] op_sel:[1,1,0] op_sel_hi:[1,0,1] neg_lo:[1,0,0]
    v_cvt_pk_f16_f32 v175, v134, v136
    v_cvt_pk_f16_f32 v191, v135, v137
    ds_write_b128 v105, v[172:175] offset:0
    ds_write_b128 v109, v[188:191] offset:0
    v_pk_mul_f32 v[8:9], v[128:129], v[48:49] op_sel:[0,0] op_sel_hi:[0,1]
    v_pk_fma_f32 v[138:139], v[128:129], v[48:49], v[8:9] op_sel:[1,1,0] op_sel_hi:[1,0,1] neg_lo:[1,0,0]
    v_pk_mul_f32 v[8:9], v[132:133], v[48:49] op_sel:[0,0] op_sel_hi:[0,1]
    v_pk_fma_f32 v[140:141], v[132:133], v[48:49], v[8:9] op_sel:[1,1,0] op_sel_hi:[1,0,1] neg_lo:[1,0,0]
    v_cvt_pk_f16_f32 v176, v138, v140
    v_cvt_pk_f16_f32 v192, v139, v141
    v_pk_mul_f32 v[8:9], v[136:137], v[48:49] op_sel:[0,0] op_sel_hi:[0,1]
    v_pk_fma_f32 v[142:143], v[136:137], v[48:49], v[8:9] op_sel:[1,1,0] op_sel_hi:[1,0,1] neg_lo:[1,0,0]
    v_pk_mul_f32 v[8:9], v[138:139], v[48:49] op_sel:[0,0] op_sel_hi:[0,1]
    v_pk_fma_f32 v[144:145], v[138:139], v[48:49], v[8:9] op_sel:[1,1,0] op_sel_hi:[1,0,1] neg_lo:[1,0,0]
    v_pk_mul_f32 v[8:9], v[140:141], v[48:49] op_sel:[0,0] op_sel_hi:[0,1]
    v_pk_fma_f32 v[146:147], v[140:141], v[48:49], v[8:9] op_sel:[1,1,0] op_sel_hi:[1,0,1] neg_lo:[1,0,0]
    v_cvt_pk_f16_f32 v178, v144, v146
    v_cvt_pk_f16_f32 v194, v145, v147
    v_pk_mul_f32 v[8:9], v[142:143], v[48:49] op_sel:[0,0] op_sel_hi:[0,1]
    v_pk_fma_f32 v[148:149], v[142:143], v[48:49], v[8:9] op_sel:[1,1,0] op_sel_hi:[1,0,1] neg_lo:[1,0,0]
    v_pk_mul_f32 v[8:9], v[144:145], v[48:49] op_sel:[0,0] op_sel_hi:[0,1]
    v_pk_fma_f32 v[150:151], v[144:145], v[48:49], v[8:9] op_sel:[1,1,0] op_sel_hi:[1,0,1] neg_lo:[1,0,0]
    v_cvt_pk_f16_f32 v177, v142, v150
    v_cvt_pk_f16_f32 v193, v143, v151
    v_pk_mul_f32 v[8:9], v[148:149], v[48:49] op_sel:[0,0] op_sel_hi:[0,1]
    v_pk_fma_f32 v[152:153], v[148:149], v[48:49], v[8:9] op_sel:[1,1,0] op_sel_hi:[1,0,1] neg_lo:[1,0,0]
    v_pk_mul_f32 v[8:9], v[150:151], v[48:49] op_sel:[0,0] op_sel_hi:[0,1]
    v_pk_fma_f32 v[154:155], v[150:151], v[48:49], v[8:9] op_sel:[1,1,0] op_sel_hi:[1,0,1] neg_lo:[1,0,0]
    v_cvt_pk_f16_f32 v180, v152, v154
    v_cvt_pk_f16_f32 v196, v153, v155
    v_pk_mul_f32 v[8:9], v[152:153], v[48:49] op_sel:[0,0] op_sel_hi:[0,1]
    v_pk_fma_f32 v[156:157], v[152:153], v[48:49], v[8:9] op_sel:[1,1,0] op_sel_hi:[1,0,1] neg_lo:[1,0,0]
    v_cvt_pk_f16_f32 v181, v156, v156
    v_cvt_pk_f16_f32 v197, v157, v157
    v_pk_mul_f32 v[8:9], v[154:155], v[48:49] op_sel:[0,0] op_sel_hi:[0,1]
    v_pk_fma_f32 v[158:159], v[154:155], v[48:49], v[8:9] op_sel:[1,1,0] op_sel_hi:[1,0,1] neg_lo:[1,0,0]
    v_cvt_pk_f16_f32 v179, v148, v158
    v_cvt_pk_f16_f32 v195, v149, v159
    ds_write_b128 v106, v[176:179] offset:0
    ds_write_b128 v110, v[192:195] offset:0
    v_pk_mul_f32 v[8:9], v[156:157], v[48:49] op_sel:[0,0] op_sel_hi:[0,1]
    v_pk_fma_f32 v[160:161], v[156:157], v[48:49], v[8:9] op_sel:[1,1,0] op_sel_hi:[1,0,1] neg_lo:[1,0,0]
    v_pk_mul_f32 v[8:9], v[158:159], v[48:49] op_sel:[0,0] op_sel_hi:[0,1]
    v_pk_fma_f32 v[162:163], v[158:159], v[48:49], v[8:9] op_sel:[1,1,0] op_sel_hi:[1,0,1] neg_lo:[1,0,0]
    v_cvt_pk_f16_f32 v182, v160, v162
    v_cvt_pk_f16_f32 v198, v161, v163
    v_pk_mul_f32 v[8:9], v[160:161], v[48:49] op_sel:[0,0] op_sel_hi:[0,1]
    v_pk_fma_f32 v[164:165], v[160:161], v[48:49], v[8:9] op_sel:[1,1,0] op_sel_hi:[1,0,1] neg_lo:[1,0,0]
    v_cvt_pk_f16_f32 v183, v164, v164
    v_cvt_pk_f16_f32 v199, v165, v165
    ds_write_b128 v107, v[180:183] offset:0
    ds_write_b128 v111, v[196:199] offset:0
    ds_read_b64_tr_b16 v[88:89], v4 offset:0
    ds_read_b64_tr_b16 v[90:91], v5 offset:0
    ds_read_b64_tr_b16 v[92:93], v4 offset:8192
    ds_read_b64_tr_b16 v[94:95], v5 offset:8192
    ds_read_b64_tr_b16 v[96:97], v4 offset:1024
    ds_read_b64_tr_b16 v[98:99], v5 offset:1024
    ds_read_b64_tr_b16 v[100:101], v4 offset:9216
    ds_read_b64_tr_b16 v[102:103], v5 offset:9216
    v_mov_b32 v32, v34
    v_mov_b32 v33, v35
    v_mov_b32 v34, v36
    v_mov_b32 v35, v37
    v_mov_b32 v38, v40
    v_mov_b32 v39, v41
    v_mov_b32 v40, v42
    v_mov_b32 v41, v43
    s_waitcnt lgkmcnt(4)
    v_mfma_f32_32x32x16_f16 v[72:87], v[88:91], v[92:95], v[72:87]
    ds_read_b64_tr_b16 v[88:89], v4 offset:2048
    ds_read_b64_tr_b16 v[90:91], v5 offset:2048
    ds_read_b64_tr_b16 v[92:93], v4 offset:10240
    ds_read_b64_tr_b16 v[94:95], v5 offset:10240
    s_waitcnt lgkmcnt(4)
    v_mfma_f32_32x32x16_f16 v[72:87], v[96:99], v[100:103], v[72:87]
    ds_read_b64_tr_b16 v[96:97], v4 offset:3072
    ds_read_b64_tr_b16 v[98:99], v5 offset:3072
    ds_read_b64_tr_b16 v[100:101], v4 offset:11264
    ds_read_b64_tr_b16 v[102:103], v5 offset:11264
    s_waitcnt lgkmcnt(4)
    v_mfma_f32_32x32x16_f16 v[72:87], v[88:91], v[92:95], v[72:87]
    ds_read_b64_tr_b16 v[88:89], v4 offset:4096
    ds_read_b64_tr_b16 v[90:91], v5 offset:4096
    ds_read_b64_tr_b16 v[92:93], v4 offset:12288
    ds_read_b64_tr_b16 v[94:95], v5 offset:12288
    s_waitcnt lgkmcnt(4)
    v_mfma_f32_32x32x16_f16 v[72:87], v[96:99], v[100:103], v[72:87]
    ds_read_b64_tr_b16 v[96:97], v4 offset:5120
    ds_read_b64_tr_b16 v[98:99], v5 offset:5120
    ds_read_b64_tr_b16 v[100:101], v4 offset:13312
    ds_read_b64_tr_b16 v[102:103], v5 offset:13312
    s_waitcnt lgkmcnt(4)
    v_mfma_f32_32x32x16_f16 v[72:87], v[88:91], v[92:95], v[72:87]
    ds_read_b64_tr_b16 v[88:89], v4 offset:6144
    ds_read_b64_tr_b16 v[90:91], v5 offset:6144
    ds_read_b64_tr_b16 v[92:93], v4 offset:14336
    ds_read_b64_tr_b16 v[94:95], v5 offset:14336
    s_waitcnt lgkmcnt(4)
    v_mfma_f32_32x32x16_f16 v[72:87], v[96:99], v[100:103], v[72:87]
    ds_read_b64_tr_b16 v[96:97], v4 offset:7168
    ds_read_b64_tr_b16 v[98:99], v5 offset:7168
    ds_read_b64_tr_b16 v[100:101], v4 offset:15360
    ds_read_b64_tr_b16 v[102:103], v5 offset:15360
    s_waitcnt lgkmcnt(4)
    v_mfma_f32_32x32x16_f16 v[72:87], v[88:91], v[92:95], v[72:87]
    s_waitcnt lgkmcnt(0)
    v_mfma_f32_32x32x16_f16 v[72:87], v[96:99], v[100:103], v[72:87]
    s_sub_u32 s89, s89, 1
    s_cmp_lg_u32 s89, 0
    s_cbranch_scc1 L_kg_chunk
    v_lshlrev_b32 v10, 4, v6
    v_sub_u32 v10, 4080, v10
    v_add_u32 v10, s83, v10
    v_lshlrev_b32 v11, 9, v7
    v_sub_u32 v12, v10, v11
    v_subrev_u32 v12, 1024, v12
    v_sub_u32 v13, v10, v11
    v_sub_u32 v13, v13, v11
    v_subrev_u32 v13, 2560, v13
    v_and_b32 v14, 1, v1
    v_cmp_eq_u32 vcc, 0, v14
    s_nop 7
    v_mul_f32 v72, s88, v72
    v_mul_f32 v73, s88, v73
    v_mul_f32 v74, s88, v74
    v_mul_f32 v75, s88, v75
    v_mul_f32 v76, s88, v76
    v_mul_f32 v77, s88, v77
    v_mul_f32 v78, s88, v78
    v_mul_f32 v79, s88, v79
    v_mul_f32 v80, s88, v80
    v_mul_f32 v81, s88, v81
    v_mul_f32 v82, s88, v82
    v_mul_f32 v83, s88, v83
    v_mul_f32 v84, s88, v84
    v_mul_f32 v85, s88, v85
    v_mul_f32 v86, s88, v86
    v_cvt_pk_bf16_f32 v88, v79, v78
    v_cvt_pk_bf16_f32 v89, v77, v76
    v_cvt_pk_bf16_f32 v90, v75, v74
    v_cvt_pk_bf16_f32 v91, v73, v72
    ds_write_b128 v12, v[88:91] offset:1024
    v_cvt_pk_bf16_f32 v92, v82, v82
    v_cvt_pk_bf16_f32 v93, v81, v81
    v_cvt_pk_bf16_f32 v94, v81, v80
    v_cvt_pk_bf16_f32 v95, v80, v80
    ds_write_b128 v12, v[92:95]
    v_cndmask_b32 v14, v84, v83, vcc
    v_cvt_pk_bf16_f32 v96, v84, v84
    v_cvt_pk_bf16_f32 v97, v84, v14
    v_cvt_pk_bf16_f32 v98, v83, v83
    v_mov_b32 v99, v98
    ds_write_b128 v13, v[96:99] offset:512
    v_cndmask_b32 v14, v86, v85, vcc
    v_cvt_pk_bf16_f32 v100, v86, v86
    v_cvt_pk_bf16_f32 v101, v86, v14
    v_cvt_pk_bf16_f32 v102, v85, v85
    v_mov_b32 v103, v102
    ds_write_b128 v13, v[100:103] offset:0
    v_lshrrev_b32 v10, 2, v1
    v_mul_u32_u24 v10, 4160, v10
    v_and_b32 v11, 3, v1
    v_lshl_add_u32 v10, v11, 4, v10
    v_add_u32 v10, 4096, v10
    v_subrev_u32 v11, 16, v1
    v_min_u32 v11, 29, v11
    v_lshlrev_b32 v11, 4, v11
    v_add_u32 v11, 16640, v11
    v_cmp_gt_u32 vcc, 16, v1
    s_nop 1
    v_cndmask_b32 v10, v11, v10, vcc
    v_add_u32 v10, s83, v10
    v_mov_b32 v16, 0
    v_mov_b32 v17, 0
    v_mov_b32 v18, 0
    v_mov_b32 v19, 0
    ds_write_b128 v10, v[16:19]
    v_lshlrev_b32 v10, 4, v1
    v_add_u32 v10, s83, v10
    ds_read_b128 v[32:35], v10 offset:0
    ds_read_b64 v[36:37], v10 offset:16
    ds_read_b128 v[40:43], v10 offset:1024
    ds_read_b64 v[44:45], v10 offset:1040
    ds_read_b128 v[48:51], v10 offset:2048
    ds_read_b64 v[52:53], v10 offset:2064
    ds_read_b128 v[56:59], v10 offset:3072
    ds_read_b64 v[60:61], v10 offset:3088
    s_waitcnt lgkmcnt(0)
    v_alignbyte_b32 v64, v33, v32, 2
    v_alignbyte_b32 v65, v34, v33, 2
    v_alignbyte_b32 v66, v35, v34, 2
    v_alignbyte_b32 v67, v36, v35, 2
    ds_write_b128 v10, v[64:67] offset:4160
    v_mov_b32 v68, v33
    v_mov_b32 v69, v34
    v_mov_b32 v70, v35
    v_mov_b32 v71, v36
    ds_write_b128 v10, v[68:71] offset:8320
    v_alignbyte_b32 v72, v34, v33, 2
    v_alignbyte_b32 v73, v35, v34, 2
    v_alignbyte_b32 v74, v36, v35, 2
    v_alignbyte_b32 v75, v37, v36, 2
    ds_write_b128 v10, v[72:75] offset:12480
    v_alignbyte_b32 v76, v41, v40, 2
    v_alignbyte_b32 v77, v42, v41, 2
    v_alignbyte_b32 v78, v43, v42, 2
    v_alignbyte_b32 v79, v44, v43, 2
    ds_write_b128 v10, v[76:79] offset:5184
    v_mov_b32 v80, v41
    v_mov_b32 v81, v42
    v_mov_b32 v82, v43
    v_mov_b32 v83, v44
    ds_write_b128 v10, v[80:83] offset:9344
    v_alignbyte_b32 v84, v42, v41, 2
    v_alignbyte_b32 v85, v43, v42, 2
    v_alignbyte_b32 v86, v44, v43, 2
    v_alignbyte_b32 v87, v45, v44, 2
    ds_write_b128 v10, v[84:87] offset:13504
    v_alignbyte_b32 v64, v49, v48, 2
    v_alignbyte_b32 v65, v50, v49, 2
    v_alignbyte_b32 v66, v51, v50, 2
    v_alignbyte_b32 v67, v52, v51, 2
    ds_write_b128 v10, v[64:67] offset:6208
    v_mov_b32 v68, v49
    v_mov_b32 v69, v50
    v_mov_b32 v70, v51
    v_mov_b32 v71, v52
    ds_write_b128 v10, v[68:71] offset:10368
    v_alignbyte_b32 v72, v50, v49, 2
    v_alignbyte_b32 v73, v51, v50, 2
    v_alignbyte_b32 v74, v52, v51, 2
    v_alignbyte_b32 v75, v53, v52, 2
    ds_write_b128 v10, v[72:75] offset:14528
    v_alignbyte_b32 v76, v57, v56, 2
    v_alignbyte_b32 v77, v58, v57, 2
    v_alignbyte_b32 v78, v59, v58, 2
    v_alignbyte_b32 v79, v60, v59, 2
    ds_write_b128 v10, v[76:79] offset:7232
    v_mov_b32 v80, v57
    v_mov_b32 v81, v58
    v_mov_b32 v82, v59
    v_mov_b32 v83, v60
    ds_write_b128 v10, v[80:83] offset:11392
    v_alignbyte_b32 v84, v58, v57, 2
    v_alignbyte_b32 v85, v59, v58, 2
    v_alignbyte_b32 v86, v60, v59, 2
    v_alignbyte_b32 v87, v61, v60, 2
    ds_write_b128 v10, v[84:87] offset:15552
    s_cmp_eq_u32 s91, 0
    s_cbranch_scc1 L_u_have
    s_mov_b32 s89, 100000
L_pu_spin:
    buffer_load_dword v12, v248, s[68:71], s90 offen sc1
    s_waitcnt vmcnt(0)
    v_cmp_ne_u32 vcc, s80, v12
    s_cbranch_vccz L_pu_done
    s_sleep 2
    s_sub_u32 s89, s89, 1
    s_cmp_lg_u32 s89, 0
    s_cbranch_scc1 L_pu_spin
L_pu_done:
    buffer_load_dwordx4 v[232:235], v249, s[68:71], s92 offen offset:0 sc1
    buffer_load_dwordx4 v[236:239], v249, s[68:71], s92 offen offset:1024 sc1
    buffer_load_dwordx4 v[240:243], v249, s[68:71], s92 offen offset:2048 sc1
    buffer_load_dwordx4 v[244:247], v249, s[68:71], s92 offen offset:3072 sc1
L_u_have:
    s_lshl_b32 s86, s82, 12
    v_and_b32 v12, 15, v1
    v_lshrrev_b32 v13, 4, v1
    v_sub_u32 v14, 3, v12
    v_and_b32 v14, 3, v14
    v_mul_u32_u24 v4, 4160, v14
    v_add_u32 v15, v12, v14
    v_sub_u32 v15, 2031, v15
    v_lshl_add_u32 v15, v13, 3, v15
    v_lshl_add_u32 v4, v15, 1, v4
    v_subrev_u32 v4, 3584, v4
    v_add_u32 v4, s83, v4
    v_lshlrev_b32 v5, 5, v12
    v_lshl_add_u32 v5, v13, 4, v5
    v_add_u32 v5, 17088, v5
    v_add_u32 v5, s83, v5
    v_lshlrev_b32 v6, 5, v12
    v_lshl_add_u32 v6, v13, 3, v6
    v_add_u32 v6, 17120, v6
    v_add_u32 v6, s83, v6
    v_lshlrev_b32 v7, 5, v12
    v_lshrrev_b32 v15, 1, v13
    v_lshl_add_u32 v7, v15, 4, v7
    v_and_b32 v15, 1, v13
    v_lshl_add_u32 v7, v15, 9, v7
    v_mov_b32 v64, 0
    v_mov_b32 v65, 0
    v_mov_b32 v66, 0
    v_mov_b32 v67, 0
    v_mov_b32 v68, 0
    v_mov_b32 v69, 0
    v_mov_b32 v70, 0
    v_mov_b32 v71, 0
    v_mov_b32 v72, 0
    v_mov_b32 v73, 0
    v_mov_b32 v74, 0
    v_mov_b32 v75, 0
    v_mov_b32 v76, 0
    v_mov_b32 v77, 0
    v_mov_b32 v78, 0
    v_mov_b32 v79, 0
    v_mov_b32 v80, 0
    v_mov_b32 v81, 0
    v_mov_b32 v82, 0
    v_mov_b32 v83, 0
    v_mov_b32 v84, 0
    v_mov_b32 v85, 0
    v_mov_b32 v86, 0
    v_mov_b32 v87, 0
    v_mov_b32 v88, 0
    v_mov_b32 v89, 0
    v_mov_b32 v90, 0
    v_mov_b32 v91, 0
    v_mov_b32 v92, 0
    v_mov_b32 v93, 0
    v_mov_b32 v94, 0
    v_mov_b32 v95, 0
    s_waitcnt vmcnt(3)
    ds_write_b128 v10, v[232:235] offset:17120
    s_waitcnt vmcnt(2)
    ds_write_b128 v10, v[236:239] offset:18144
    s_waitcnt vmcnt(1)
    ds_write_b128 v10, v[240:243] offset:19168
    s_waitcnt vmcnt(0)
    ds_write_b128 v10, v[244:247] offset:20192
    ds_read_b64 v[96:97], v4 offset:3584
    ds_read_b64 v[98:99], v4 offset:3592
    ds_read_b128 v[128:131], v5 offset:0
    ds_read_b64 v[100:101], v4 offset:3072
    ds_read_b64 v[102:103], v4 offset:3080
    ds_read_b128 v[132:135], v5 offset:512
    ds_read_b64 v[104:105], v4 offset:2560
    ds_read_b64 v[106:107], v4 offset:2568
    ds_read_b128 v[136:139], v5 offset:1024
    ds_read_b64 v[108:109], v4 offset:2048
    ds_read_b64 v[110:111], v4 offset:2056
    ds_read_b128 v[140:143], v5 offset:1536
    ds_read_b64 v[112:113], v4 offset:1536
    ds_read_b64 v[114:115], v4 offset:1544
    ds_read_b128 v[144:147], v5 offset:2048
    ds_read_b64 v[116:117], v4 offset:1024
    ds_read_b64 v[118:119], v4 offset:1032
    ds_read_b128 v[148:151], v5 offset:2560
    ds_read_b64 v[120:121], v4 offset:512
    ds_read_b64 v[122:123], v4 offset:520
    ds_read_b128 v[152:155], v5 offset:3072
    ds_read_b64 v[124:125], v4 offset:0
    ds_read_b64 v[126:127], v4 offset:8
    ds_read_b128 v[156:159], v5 offset:3584
    s_mov_b32 s89, 4
L_conv:
    v_subrev_u32 v4, 64, v4
    v_subrev_u32 v5, 64, v5
    s_waitcnt lgkmcnt(0)
    v_mfma_f32_16x16x32_bf16 v[64:67], v[96:99], v[128:131], v[64:67]
    v_mfma_f32_16x16x32_bf16 v[68:71], v[96:99], v[132:135], v[68:71]
    v_mfma_f32_16x16x32_bf16 v[72:75], v[96:99], v[136:139], v[72:75]
    ds_read_b64 v[160:161], v4 offset:3584
    v_mfma_f32_16x16x32_bf16 v[76:79], v[96:99], v[140:143], v[76:79]
    ds_read_b64 v[162:163], v4 offset:3592
    v_mfma_f32_16x16x32_bf16 v[80:83], v[96:99], v[144:147], v[80:83]
    ds_read_b128 v[192:195], v5 offset:0
    v_mfma_f32_16x16x32_bf16 v[84:87], v[96:99], v[148:151], v[84:87]
    ds_read_b64 v[164:165], v4 offset:3072
    v_mfma_f32_16x16x32_bf16 v[88:91], v[96:99], v[152:155], v[88:91]
    ds_read_b64 v[166:167], v4 offset:3080
    v_mfma_f32_16x16x32_bf16 v[92:95], v[96:99], v[156:159], v[92:95]
    ds_read_b128 v[196:199], v5 offset:512
    v_mfma_f32_16x16x32_bf16 v[68:71], v[100:103], v[128:131], v[68:71]
    ds_read_b64 v[168:169], v4 offset:2560
    v_mfma_f32_16x16x32_bf16 v[72:75], v[100:103], v[132:135], v[72:75]
    ds_read_b64 v[170:171], v4 offset:2568
    v_mfma_f32_16x16x32_bf16 v[76:79], v[100:103], v[136:139], v[76:79]
    ds_read_b128 v[200:203], v5 offset:1024
    v_mfma_f32_16x16x32_bf16 v[80:83], v[100:103], v[140:143], v[80:83]
    ds_read_b64 v[172:173], v4 offset:2048
    v_mfma_f32_16x16x32_bf16 v[84:87], v[100:103], v[144:147], v[84:87]
    ds_read_b64 v[174:175], v4 offset:2056
    v_mfma_f32_16x16x32_bf16 v[88:91], v[100:103], v[148:151], v[88:91]
    ds_read_b128 v[204:207], v5 offset:1536
    v_mfma_f32_16x16x32_bf16 v[92:95], v[100:103], v[152:155], v[92:95]
    ds_read_b64 v[176:177], v4 offset:1536
    v_mfma_f32_16x16x32_bf16 v[72:75], v[104:107], v[128:131], v[72:75]
    ds_read_b64 v[178:179], v4 offset:1544
    v_mfma_f32_16x16x32_bf16 v[76:79], v[104:107], v[132:135], v[76:79]
    ds_read_b128 v[208:211], v5 offset:2048
    v_mfma_f32_16x16x32_bf16 v[80:83], v[104:107], v[136:139], v[80:83]
    ds_read_b64 v[180:181], v4 offset:1024
    v_mfma_f32_16x16x32_bf16 v[84:87], v[104:107], v[140:143], v[84:87]
    ds_read_b64 v[182:183], v4 offset:1032
    v_mfma_f32_16x16x32_bf16 v[88:91], v[104:107], v[144:147], v[88:91]
    ds_read_b128 v[212:215], v5 offset:2560
    v_mfma_f32_16x16x32_bf16 v[92:95], v[104:107], v[148:151], v[92:95]
    ds_read_b64 v[184:185], v4 offset:512
    v_mfma_f32_16x16x32_bf16 v[76:79], v[108:111], v[128:131], v[76:79]
    ds_read_b64 v[186:187], v4 offset:520
    v_mfma_f32_16x16x32_bf16 v[80:83], v[108:111], v[132:135], v[80:83]
    ds_read_b128 v[216:219], v5 offset:3072
    v_mfma_f32_16x16x32_bf16 v[84:87], v[108:111], v[136:139], v[84:87]
    ds_read_b64 v[188:189], v4 offset:0
    v_mfma_f32_16x16x32_bf16 v[88:91], v[108:111], v[140:143], v[88:91]
    ds_read_b64 v[190:191], v4 offset:8
    v_mfma_f32_16x16x32_bf16 v[92:95], v[108:111], v[144:147], v[92:95]
    ds_read_b128 v[220:223], v5 offset:3584
    v_mfma_f32_16x16x32_bf16 v[80:83], v[112:115], v[128:131], v[80:83]
    v_mfma_f32_16x16x32_bf16 v[84:87], v[112:115], v[132:135], v[84:87]
    v_mfma_f32_16x16x32_bf16 v[88:91], v[112:115], v[136:139], v[88:91]
    v_mfma_f32_16x16x32_bf16 v[92:95], v[112:115], v[140:143], v[92:95]
    v_mfma_f32_16x16x32_bf16 v[84:87], v[116:119], v[128:131], v[84:87]
    v_mfma_f32_16x16x32_bf16 v[88:91], v[116:119], v[132:135], v[88:91]
    v_mfma_f32_16x16x32_bf16 v[92:95], v[116:119], v[136:139], v[92:95]
    v_mfma_f32_16x16x32_bf16 v[88:91], v[120:123], v[128:131], v[88:91]
    v_mfma_f32_16x16x32_bf16 v[92:95], v[120:123], v[132:135], v[92:95]
    v_mfma_f32_16x16x32_bf16 v[92:95], v[124:127], v[128:131], v[92:95]
    v_subrev_u32 v4, 64, v4
    v_subrev_u32 v5, 64, v5
    s_waitcnt lgkmcnt(0)
    v_mfma_f32_16x16x32_bf16 v[64:67], v[160:163], v[192:195], v[64:67]
    v_mfma_f32_16x16x32_bf16 v[68:71], v[160:163], v[196:199], v[68:71]
    v_mfma_f32_16x16x32_bf16 v[72:75], v[160:163], v[200:203], v[72:75]
    ds_read_b64 v[96:97], v4 offset:3584
    v_mfma_f32_16x16x32_bf16 v[76:79], v[160:163], v[204:207], v[76:79]
    ds_read_b64 v[98:99], v4 offset:3592
    v_mfma_f32_16x16x32_bf16 v[80:83], v[160:163], v[208:211], v[80:83]
    ds_read_b128 v[128:131], v5 offset:0
    v_mfma_f32_16x16x32_bf16 v[84:87], v[160:163], v[212:215], v[84:87]
    ds_read_b64 v[100:101], v4 offset:3072
    v_mfma_f32_16x16x32_bf16 v[88:91], v[160:163], v[216:219], v[88:91]
    ds_read_b64 v[102:103], v4 offset:3080
    v_mfma_f32_16x16x32_bf16 v[92:95], v[160:163], v[220:223], v[92:95]
    ds_read_b128 v[132:135], v5 offset:512
    v_mfma_f32_16x16x32_bf16 v[68:71], v[164:167], v[192:195], v[68:71]
    ds_read_b64 v[104:105], v4 offset:2560
    v_mfma_f32_16x16x32_bf16 v[72:75], v[164:167], v[196:199], v[72:75]
    ds_read_b64 v[106:107], v4 offset:2568
    v_mfma_f32_16x16x32_bf16 v[76:79], v[164:167], v[200:203], v[76:79]
    ds_read_b128 v[136:139], v5 offset:1024
    v_mfma_f32_16x16x32_bf16 v[80:83], v[164:167], v[204:207], v[80:83]
    ds_read_b64 v[108:109], v4 offset:2048
    v_mfma_f32_16x16x32_bf16 v[84:87], v[164:167], v[208:211], v[84:87]
    ds_read_b64 v[110:111], v4 offset:2056
    v_mfma_f32_16x16x32_bf16 v[88:91], v[164:167], v[212:215], v[88:91]
    ds_read_b128 v[140:143], v5 offset:1536
    v_mfma_f32_16x16x32_bf16 v[92:95], v[164:167], v[216:219], v[92:95]
    ds_read_b64 v[112:113], v4 offset:1536
    v_mfma_f32_16x16x32_bf16 v[72:75], v[168:171], v[192:195], v[72:75]
    ds_read_b64 v[114:115], v4 offset:1544
    v_mfma_f32_16x16x32_bf16 v[76:79], v[168:171], v[196:199], v[76:79]
    ds_read_b128 v[144:147], v5 offset:2048
    v_mfma_f32_16x16x32_bf16 v[80:83], v[168:171], v[200:203], v[80:83]
    ds_read_b64 v[116:117], v4 offset:1024
    v_mfma_f32_16x16x32_bf16 v[84:87], v[168:171], v[204:207], v[84:87]
    ds_read_b64 v[118:119], v4 offset:1032
    v_mfma_f32_16x16x32_bf16 v[88:91], v[168:171], v[208:211], v[88:91]
    ds_read_b128 v[148:151], v5 offset:2560
    v_mfma_f32_16x16x32_bf16 v[92:95], v[168:171], v[212:215], v[92:95]
    ds_read_b64 v[120:121], v4 offset:512
    v_mfma_f32_16x16x32_bf16 v[76:79], v[172:175], v[192:195], v[76:79]
    ds_read_b64 v[122:123], v4 offset:520
    v_mfma_f32_16x16x32_bf16 v[80:83], v[172:175], v[196:199], v[80:83]
    ds_read_b128 v[152:155], v5 offset:3072
    v_mfma_f32_16x16x32_bf16 v[84:87], v[172:175], v[200:203], v[84:87]
    ds_read_b64 v[124:125], v4 offset:0
    v_mfma_f32_16x16x32_bf16 v[88:91], v[172:175], v[204:207], v[88:91]
    ds_read_b64 v[126:127], v4 offset:8
    v_mfma_f32_16x16x32_bf16 v[92:95], v[172:175], v[208:211], v[92:95]
    ds_read_b128 v[156:159], v5 offset:3584
    v_mfma_f32_16x16x32_bf16 v[80:83], v[176:179], v[192:195], v[80:83]
    v_mfma_f32_16x16x32_bf16 v[84:87], v[176:179], v[196:199], v[84:87]
    v_mfma_f32_16x16x32_bf16 v[88:91], v[176:179], v[200:203], v[88:91]
    v_mfma_f32_16x16x32_bf16 v[92:95], v[176:179], v[204:207], v[92:95]
    v_mfma_f32_16x16x32_bf16 v[84:87], v[180:183], v[192:195], v[84:87]
    v_mfma_f32_16x16x32_bf16 v[88:91], v[180:183], v[196:199], v[88:91]
    v_mfma_f32_16x16x32_bf16 v[92:95], v[180:183], v[200:203], v[92:95]
    v_mfma_f32_16x16x32_bf16 v[88:91], v[184:187], v[192:195], v[88:91]
    v_mfma_f32_16x16x32_bf16 v[92:95], v[184:187], v[196:199], v[92:95]
    v_mfma_f32_16x16x32_bf16 v[92:95], v[188:191], v[192:195], v[92:95]
    s_sub_u32 s89, s89, 1
    s_cmp_lg_u32 s89, 0
    s_cbranch_scc1 L_conv
    s_waitcnt lgkmcnt(0)
    v_mov_b32 v28, v29
    ds_read_b64 v[32:33], v6 offset:0
    ds_read_b64 v[34:35], v6 offset:512
    ds_read_b64 v[36:37], v6 offset:1024
    ds_read_b64 v[38:39], v6 offset:1536
    ds_read_b64 v[40:41], v6 offset:2048
    ds_read_b64 v[42:43], v6 offset:2560
    ds_read_b64 v[44:45], v6 offset:3072
    ds_read_b64 v[46:47], v6 offset:3584
    s_add_u32 s87, s86, 10485760
    s_waitcnt lgkmcnt(0)
    v_cvt_pk_bf16_f32 v112, v64, v65
    v_cvt_pk_bf16_f32 v113, v66, v67
    v_lshlrev_b32 v64, 16, v32
    v_and_b32 v65, 0xffff0000, v32
    v_lshlrev_b32 v66, 16, v33
    v_and_b32 v67, 0xffff0000, v33
    v_pk_mul_f32 v[64:65], v[64:65], v[28:29]
    v_pk_mul_f32 v[66:67], v[66:67], v[28:29]
    v_cvt_pk_bf16_f32 v114, v64, v65
    v_cvt_pk_bf16_f32 v115, v66, v67
    v_lshlrev_b32 v64, 16, v112
    v_and_b32 v65, 0xffff0000, v112
    v_lshlrev_b32 v66, 16, v113
    v_and_b32 v67, 0xffff0000, v113
    v_lshlrev_b32 v116, 16, v114
    v_and_b32 v117, 0xffff0000, v114
    v_lshlrev_b32 v118, 16, v115
    v_and_b32 v119, 0xffff0000, v115
    v_pk_add_f32 v[64:65], v[64:65], v[116:117]
    v_pk_add_f32 v[66:67], v[66:67], v[118:119]
    v_cvt_pk_bf16_f32 v96, v64, v65
    v_cvt_pk_bf16_f32 v97, v66, v67
    v_cvt_pk_bf16_f32 v120, v68, v69
    v_cvt_pk_bf16_f32 v121, v70, v71
    v_lshlrev_b32 v68, 16, v34
    v_and_b32 v69, 0xffff0000, v34
    v_lshlrev_b32 v70, 16, v35
    v_and_b32 v71, 0xffff0000, v35
    v_pk_mul_f32 v[68:69], v[68:69], v[28:29]
    v_pk_mul_f32 v[70:71], v[70:71], v[28:29]
    v_cvt_pk_bf16_f32 v122, v68, v69
    v_cvt_pk_bf16_f32 v123, v70, v71
    v_lshlrev_b32 v68, 16, v120
    v_and_b32 v69, 0xffff0000, v120
    v_lshlrev_b32 v70, 16, v121
    v_and_b32 v71, 0xffff0000, v121
    v_lshlrev_b32 v124, 16, v122
    v_and_b32 v125, 0xffff0000, v122
    v_lshlrev_b32 v126, 16, v123
    v_and_b32 v127, 0xffff0000, v123
    v_pk_add_f32 v[68:69], v[68:69], v[124:125]
    v_pk_add_f32 v[70:71], v[70:71], v[126:127]
    v_cvt_pk_bf16_f32 v98, v68, v69
    v_cvt_pk_bf16_f32 v99, v70, v71
    s_nop 0
    v_permlane16_swap_b32 v96, v98
    v_permlane16_swap_b32 v97, v99
    buffer_store_dwordx4 v[96:99], v7, s[68:71], s87 offen offset:0 sc1
    v_cvt_pk_bf16_f32 v112, v72, v73
    v_cvt_pk_bf16_f32 v113, v74, v75
    v_lshlrev_b32 v72, 16, v36
    v_and_b32 v73, 0xffff0000, v36
    v_lshlrev_b32 v74, 16, v37
    v_and_b32 v75, 0xffff0000, v37
    v_pk_mul_f32 v[72:73], v[72:73], v[28:29]
    v_pk_mul_f32 v[74:75], v[74:75], v[28:29]
    v_cvt_pk_bf16_f32 v114, v72, v73
    v_cvt_pk_bf16_f32 v115, v74, v75
    v_lshlrev_b32 v72, 16, v112
    v_and_b32 v73, 0xffff0000, v112
    v_lshlrev_b32 v74, 16, v113
    v_and_b32 v75, 0xffff0000, v113
    v_lshlrev_b32 v116, 16, v114
    v_and_b32 v117, 0xffff0000, v114
    v_lshlrev_b32 v118, 16, v115
    v_and_b32 v119, 0xffff0000, v115
    v_pk_add_f32 v[72:73], v[72:73], v[116:117]
    v_pk_add_f32 v[74:75], v[74:75], v[118:119]
    v_cvt_pk_bf16_f32 v100, v72, v73
    v_cvt_pk_bf16_f32 v101, v74, v75
    v_cvt_pk_bf16_f32 v120, v76, v77
    v_cvt_pk_bf16_f32 v121, v78, v79
    v_lshlrev_b32 v76, 16, v38
    v_and_b32 v77, 0xffff0000, v38
    v_lshlrev_b32 v78, 16, v39
    v_and_b32 v79, 0xffff0000, v39
    v_pk_mul_f32 v[76:77], v[76:77], v[28:29]
    v_pk_mul_f32 v[78:79], v[78:79], v[28:29]
    v_cvt_pk_bf16_f32 v122, v76, v77
    v_cvt_pk_bf16_f32 v123, v78, v79
    v_lshlrev_b32 v76, 16, v120
    v_and_b32 v77, 0xffff0000, v120
    v_lshlrev_b32 v78, 16, v121
    v_and_b32 v79, 0xffff0000, v121
    v_lshlrev_b32 v124, 16, v122
    v_and_b32 v125, 0xffff0000, v122
    v_lshlrev_b32 v126, 16, v123
    v_and_b32 v127, 0xffff0000, v123
    v_pk_add_f32 v[76:77], v[76:77], v[124:125]
    v_pk_add_f32 v[78:79], v[78:79], v[126:127]
    v_cvt_pk_bf16_f32 v102, v76, v77
    v_cvt_pk_bf16_f32 v103, v78, v79
    s_nop 0
    v_permlane16_swap_b32 v100, v102
    v_permlane16_swap_b32 v101, v103
    buffer_store_dwordx4 v[100:103], v7, s[68:71], s87 offen offset:1024 sc1
    v_cvt_pk_bf16_f32 v112, v80, v81
    v_cvt_pk_bf16_f32 v113, v82, v83
    v_lshlrev_b32 v80, 16, v40
    v_and_b32 v81, 0xffff0000, v40
    v_lshlrev_b32 v82, 16, v41
    v_and_b32 v83, 0xffff0000, v41
    v_pk_mul_f32 v[80:81], v[80:81], v[28:29]
    v_pk_mul_f32 v[82:83], v[82:83], v[28:29]
    v_cvt_pk_bf16_f32 v114, v80, v81
    v_cvt_pk_bf16_f32 v115, v82, v83
    v_lshlrev_b32 v80, 16, v112
    v_and_b32 v81, 0xffff0000, v112
    v_lshlrev_b32 v82, 16, v113
    v_and_b32 v83, 0xffff0000, v113
    v_lshlrev_b32 v116, 16, v114
    v_and_b32 v117, 0xffff0000, v114
    v_lshlrev_b32 v118, 16, v115
    v_and_b32 v119, 0xffff0000, v115
    v_pk_add_f32 v[80:81], v[80:81], v[116:117]
    v_pk_add_f32 v[82:83], v[82:83], v[118:119]
    v_cvt_pk_bf16_f32 v104, v80, v81
    v_cvt_pk_bf16_f32 v105, v82, v83
    v_cvt_pk_bf16_f32 v120, v84, v85
    v_cvt_pk_bf16_f32 v121, v86, v87
    v_lshlrev_b32 v84, 16, v42
    v_and_b32 v85, 0xffff0000, v42
    v_lshlrev_b32 v86, 16, v43
    v_and_b32 v87, 0xffff0000, v43
    v_pk_mul_f32 v[84:85], v[84:85], v[28:29]
    v_pk_mul_f32 v[86:87], v[86:87], v[28:29]
    v_cvt_pk_bf16_f32 v122, v84, v85
    v_cvt_pk_bf16_f32 v123, v86, v87
    v_lshlrev_b32 v84, 16, v120
    v_and_b32 v85, 0xffff0000, v120
    v_lshlrev_b32 v86, 16, v121
    v_and_b32 v87, 0xffff0000, v121
    v_lshlrev_b32 v124, 16, v122
    v_and_b32 v125, 0xffff0000, v122
    v_lshlrev_b32 v126, 16, v123
    v_and_b32 v127, 0xffff0000, v123
    v_pk_add_f32 v[84:85], v[84:85], v[124:125]
    v_pk_add_f32 v[86:87], v[86:87], v[126:127]
    v_cvt_pk_bf16_f32 v106, v84, v85
    v_cvt_pk_bf16_f32 v107, v86, v87
    s_nop 0
    v_permlane16_swap_b32 v104, v106
    v_permlane16_swap_b32 v105, v107
    buffer_store_dwordx4 v[104:107], v7, s[68:71], s87 offen offset:2048 sc1
    v_cvt_pk_bf16_f32 v112, v88, v89
    v_cvt_pk_bf16_f32 v113, v90, v91
    v_lshlrev_b32 v88, 16, v44
    v_and_b32 v89, 0xffff0000, v44
    v_lshlrev_b32 v90, 16, v45
    v_and_b32 v91, 0xffff0000, v45
    v_pk_mul_f32 v[88:89], v[88:89], v[28:29]
    v_pk_mul_f32 v[90:91], v[90:91], v[28:29]
    v_cvt_pk_bf16_f32 v114, v88, v89
    v_cvt_pk_bf16_f32 v115, v90, v91
    v_lshlrev_b32 v88, 16, v112
    v_and_b32 v89, 0xffff0000, v112
    v_lshlrev_b32 v90, 16, v113
    v_and_b32 v91, 0xffff0000, v113
    v_lshlrev_b32 v116, 16, v114
    v_and_b32 v117, 0xffff0000, v114
    v_lshlrev_b32 v118, 16, v115
    v_and_b32 v119, 0xffff0000, v115
    v_pk_add_f32 v[88:89], v[88:89], v[116:117]
    v_pk_add_f32 v[90:91], v[90:91], v[118:119]
    v_cvt_pk_bf16_f32 v108, v88, v89
    v_cvt_pk_bf16_f32 v109, v90, v91
    v_cvt_pk_bf16_f32 v120, v92, v93
    v_cvt_pk_bf16_f32 v121, v94, v95
    v_lshlrev_b32 v92, 16, v46
    v_and_b32 v93, 0xffff0000, v46
    v_lshlrev_b32 v94, 16, v47
    v_and_b32 v95, 0xffff0000, v47
    v_pk_mul_f32 v[92:93], v[92:93], v[28:29]
    v_pk_mul_f32 v[94:95], v[94:95], v[28:29]
    v_cvt_pk_bf16_f32 v122, v92, v93
    v_cvt_pk_bf16_f32 v123, v94, v95
    v_lshlrev_b32 v92, 16, v120
    v_and_b32 v93, 0xffff0000, v120
    v_lshlrev_b32 v94, 16, v121
    v_and_b32 v95, 0xffff0000, v121
    v_lshlrev_b32 v124, 16, v122
    v_and_b32 v125, 0xffff0000, v122
    v_lshlrev_b32 v126, 16, v123
    v_and_b32 v127, 0xffff0000, v123
    v_pk_add_f32 v[92:93], v[92:93], v[124:125]
    v_pk_add_f32 v[94:95], v[94:95], v[126:127]
    v_cvt_pk_bf16_f32 v110, v92, v93
    v_cvt_pk_bf16_f32 v111, v94, v95
    s_nop 0
    v_permlane16_swap_b32 v108, v110
    v_permlane16_swap_b32 v109, v111
    buffer_store_dwordx4 v[108:111], v7, s[68:71], s87 offen offset:3072 sc1
    s_waitcnt vmcnt(0)
    s_lshl_b32 s86, s82, 2
    s_add_u32 s86, s86, 16384
    v_mov_b32 v8, s80
    s_mov_b64 exec, 1
    buffer_store_dword v8, off, s[68:71], s86 sc1
    s_endpgm
L_gate:
    s_sub_u32 s82, s2, 256
    s_and_b32 s92, s82, 7
    s_lshr_b32 s90, s92, 1
    s_lshl_b32 s90, s90, 3
    s_lshr_b32 s91, s82, 5
    s_add_u32 s90, s90, s91
    s_and_b32 s91, s92, 1
    s_lshl_b32 s91, s91, 2
    s_bfe_u32 s92, s82, 0x20003
    s_add_u32 s91, s91, s92
    s_mul_i32 s86, s82, 10240
    v_lshrrev_b32 v2, 3, v1
    v_and_b32 v3, 7, v1
    v_lshlrev_b32 v4, 4, v3
    v_mul_u32_u24 v5, 1280, v2
    v_add_u32 v5, v5, v4
    v_add_u32 v5, s86, v5
    global_load_dwordx4 v[16:19], v5, s[16:17] offset:0
    global_load_dwordx4 v[56:59], v4, s[44:45] offset:0
    global_load_dwordx4 v[20:23], v5, s[16:17] offset:128
    global_load_dwordx4 v[60:63], v4, s[44:45] offset:128
    global_load_dwordx4 v[24:27], v5, s[16:17] offset:256
    global_load_dwordx4 v[64:67], v4, s[44:45] offset:256
    global_load_dwordx4 v[28:31], v5, s[16:17] offset:384
    global_load_dwordx4 v[68:71], v4, s[44:45] offset:384
    global_load_dwordx4 v[32:35], v5, s[16:17] offset:512
    global_load_dwordx4 v[72:75], v4, s[44:45] offset:512
    global_load_dwordx4 v[36:39], v5, s[16:17] offset:640
    global_load_dwordx4 v[76:79], v4, s[44:45] offset:640
    global_load_dwordx4 v[40:43], v5, s[16:17] offset:768
    global_load_dwordx4 v[80:83], v4, s[44:45] offset:768
    global_load_dwordx4 v[44:47], v5, s[16:17] offset:896
    global_load_dwordx4 v[84:87], v4, s[44:45] offset:896
    global_load_dwordx4 v[48:51], v5, s[16:17] offset:1024
    global_load_dwordx4 v[88:91], v4, s[44:45] offset:1024
    global_load_dwordx4 v[52:55], v5, s[16:17] offset:1152
    global_load_dwordx4 v[92:95], v4, s[44:45] offset:1152
    s_waitcnt vmcnt(20)
    v_readfirstlane_b32 s80, v127
    s_nop 3
    s_add_u32 s80, s80, 1
    v_mov_b32 v6, 0
    v_mov_b32 v7, 0
    s_waitcnt vmcnt(18)
    v_lshlrev_b32 v8, 16, v16
    v_and_b32 v9, 0xffff0000, v16
    v_lshlrev_b32 v10, 16, v56
    v_and_b32 v11, 0xffff0000, v56
    v_pk_mul_f32 v[8:9], v[8:9], v[10:11]
    v_cvt_pk_bf16_f32 v12, v8, v9
    v_lshlrev_b32 v8, 16, v12
    v_and_b32 v9, 0xffff0000, v12
    v_pk_add_f32 v[6:7], v[6:7], v[8:9]
    v_lshlrev_b32 v8, 16, v17
    v_and_b32 v9, 0xffff0000, v17
    v_lshlrev_b32 v10, 16, v57
    v_and_b32 v11, 0xffff0000, v57
    v_pk_mul_f32 v[8:9], v[8:9], v[10:11]
    v_cvt_pk_bf16_f32 v12, v8, v9
    v_lshlrev_b32 v8, 16, v12
    v_and_b32 v9, 0xffff0000, v12
    v_pk_add_f32 v[6:7], v[6:7], v[8:9]
    v_lshlrev_b32 v8, 16, v18
    v_and_b32 v9, 0xffff0000, v18
    v_lshlrev_b32 v10, 16, v58
    v_and_b32 v11, 0xffff0000, v58
    v_pk_mul_f32 v[8:9], v[8:9], v[10:11]
    v_cvt_pk_bf16_f32 v12, v8, v9
    v_lshlrev_b32 v8, 16, v12
    v_and_b32 v9, 0xffff0000, v12
    v_pk_add_f32 v[6:7], v[6:7], v[8:9]
    v_lshlrev_b32 v8, 16, v19
    v_and_b32 v9, 0xffff0000, v19
    v_lshlrev_b32 v10, 16, v59
    v_and_b32 v11, 0xffff0000, v59
    v_pk_mul_f32 v[8:9], v[8:9], v[10:11]
    v_cvt_pk_bf16_f32 v12, v8, v9
    v_lshlrev_b32 v8, 16, v12
    v_and_b32 v9, 0xffff0000, v12
    v_pk_add_f32 v[6:7], v[6:7], v[8:9]
    s_waitcnt vmcnt(16)
    v_lshlrev_b32 v8, 16, v20
    v_and_b32 v9, 0xffff0000, v20
    v_lshlrev_b32 v10, 16, v60
    v_and_b32 v11, 0xffff0000, v60
    v_pk_mul_f32 v[8:9], v[8:9], v[10:11]
    v_cvt_pk_bf16_f32 v12, v8, v9
    v_lshlrev_b32 v8, 16, v12
    v_and_b32 v9, 0xffff0000, v12
    v_pk_add_f32 v[6:7], v[6:7], v[8:9]
    v_lshlrev_b32 v8, 16, v21
    v_and_b32 v9, 0xffff0000, v21
    v_lshlrev_b32 v10, 16, v61
    v_and_b32 v11, 0xffff0000, v61
    v_pk_mul_f32 v[8:9], v[8:9], v[10:11]
    v_cvt_pk_bf16_f32 v12, v8, v9
    v_lshlrev_b32 v8, 16, v12
    v_and_b32 v9, 0xffff0000, v12
    v_pk_add_f32 v[6:7], v[6:7], v[8:9]
    v_lshlrev_b32 v8, 16, v22
    v_and_b32 v9, 0xffff0000, v22
    v_lshlrev_b32 v10, 16, v62
    v_and_b32 v11, 0xffff0000, v62
    v_pk_mul_f32 v[8:9], v[8:9], v[10:11]
    v_cvt_pk_bf16_f32 v12, v8, v9
    v_lshlrev_b32 v8, 16, v12
    v_and_b32 v9, 0xffff0000, v12
    v_pk_add_f32 v[6:7], v[6:7], v[8:9]
    v_lshlrev_b32 v8, 16, v23
    v_and_b32 v9, 0xffff0000, v23
    v_lshlrev_b32 v10, 16, v63
    v_and_b32 v11, 0xffff0000, v63
    v_pk_mul_f32 v[8:9], v[8:9], v[10:11]
    v_cvt_pk_bf16_f32 v12, v8, v9
    v_lshlrev_b32 v8, 16, v12
    v_and_b32 v9, 0xffff0000, v12
    v_pk_add_f32 v[6:7], v[6:7], v[8:9]
    s_waitcnt vmcnt(14)
    v_lshlrev_b32 v8, 16, v24
    v_and_b32 v9, 0xffff0000, v24
    v_lshlrev_b32 v10, 16, v64
    v_and_b32 v11, 0xffff0000, v64
    v_pk_mul_f32 v[8:9], v[8:9], v[10:11]
    v_cvt_pk_bf16_f32 v12, v8, v9
    v_lshlrev_b32 v8, 16, v12
    v_and_b32 v9, 0xffff0000, v12
    v_pk_add_f32 v[6:7], v[6:7], v[8:9]
    v_lshlrev_b32 v8, 16, v25
    v_and_b32 v9, 0xffff0000, v25
    v_lshlrev_b32 v10, 16, v65
    v_and_b32 v11, 0xffff0000, v65
    v_pk_mul_f32 v[8:9], v[8:9], v[10:11]
    v_cvt_pk_bf16_f32 v12, v8, v9
    v_lshlrev_b32 v8, 16, v12
    v_and_b32 v9, 0xffff0000, v12
    v_pk_add_f32 v[6:7], v[6:7], v[8:9]
    v_lshlrev_b32 v8, 16, v26
    v_and_b32 v9, 0xffff0000, v26
    v_lshlrev_b32 v10, 16, v66
    v_and_b32 v11, 0xffff0000, v66
    v_pk_mul_f32 v[8:9], v[8:9], v[10:11]
    v_cvt_pk_bf16_f32 v12, v8, v9
    v_lshlrev_b32 v8, 16, v12
    v_and_b32 v9, 0xffff0000, v12
    v_pk_add_f32 v[6:7], v[6:7], v[8:9]
    v_lshlrev_b32 v8, 16, v27
    v_and_b32 v9, 0xffff0000, v27
    v_lshlrev_b32 v10, 16, v67
    v_and_b32 v11, 0xffff0000, v67
    v_pk_mul_f32 v[8:9], v[8:9], v[10:11]
    v_cvt_pk_bf16_f32 v12, v8, v9
    v_lshlrev_b32 v8, 16, v12
    v_and_b32 v9, 0xffff0000, v12
    v_pk_add_f32 v[6:7], v[6:7], v[8:9]
    s_waitcnt vmcnt(12)
    v_lshlrev_b32 v8, 16, v28
    v_and_b32 v9, 0xffff0000, v28
    v_lshlrev_b32 v10, 16, v68
    v_and_b32 v11, 0xffff0000, v68
    v_pk_mul_f32 v[8:9], v[8:9], v[10:11]
    v_cvt_pk_bf16_f32 v12, v8, v9
    v_lshlrev_b32 v8, 16, v12
    v_and_b32 v9, 0xffff0000, v12
    v_pk_add_f32 v[6:7], v[6:7], v[8:9]
    v_lshlrev_b32 v8, 16, v29
    v_and_b32 v9, 0xffff0000, v29
    v_lshlrev_b32 v10, 16, v69
    v_and_b32 v11, 0xffff0000, v69
    v_pk_mul_f32 v[8:9], v[8:9], v[10:11]
    v_cvt_pk_bf16_f32 v12, v8, v9
    v_lshlrev_b32 v8, 16, v12
    v_and_b32 v9, 0xffff0000, v12
    v_pk_add_f32 v[6:7], v[6:7], v[8:9]
    v_lshlrev_b32 v8, 16, v30
    v_and_b32 v9, 0xffff0000, v30
    v_lshlrev_b32 v10, 16, v70
    v_and_b32 v11, 0xffff0000, v70
    v_pk_mul_f32 v[8:9], v[8:9], v[10:11]
    v_cvt_pk_bf16_f32 v12, v8, v9
    v_lshlrev_b32 v8, 16, v12
    v_and_b32 v9, 0xffff0000, v12
    v_pk_add_f32 v[6:7], v[6:7], v[8:9]
    v_lshlrev_b32 v8, 16, v31
    v_and_b32 v9, 0xffff0000, v31
    v_lshlrev_b32 v10, 16, v71
    v_and_b32 v11, 0xffff0000, v71
    v_pk_mul_f32 v[8:9], v[8:9], v[10:11]
    v_cvt_pk_bf16_f32 v12, v8, v9
    v_lshlrev_b32 v8, 16, v12
    v_and_b32 v9, 0xffff0000, v12
    v_pk_add_f32 v[6:7], v[6:7], v[8:9]
    s_waitcnt vmcnt(10)
    v_lshlrev_b32 v8, 16, v32
    v_and_b32 v9, 0xffff0000, v32
    v_lshlrev_b32 v10, 16, v72
    v_and_b32 v11, 0xffff0000, v72
    v_pk_mul_f32 v[8:9], v[8:9], v[10:11]
    v_cvt_pk_bf16_f32 v12, v8, v9
    v_lshlrev_b32 v8, 16, v12
    v_and_b32 v9, 0xffff0000, v12
    v_pk_add_f32 v[6:7], v[6:7], v[8:9]
    v_lshlrev_b32 v8, 16, v33
    v_and_b32 v9, 0xffff0000, v33
    v_lshlrev_b32 v10, 16, v73
    v_and_b32 v11, 0xffff0000, v73
    v_pk_mul_f32 v[8:9], v[8:9], v[10:11]
    v_cvt_pk_bf16_f32 v12, v8, v9
    v_lshlrev_b32 v8, 16, v12
    v_and_b32 v9, 0xffff0000, v12
    v_pk_add_f32 v[6:7], v[6:7], v[8:9]
    v_lshlrev_b32 v8, 16, v34
    v_and_b32 v9, 0xffff0000, v34
    v_lshlrev_b32 v10, 16, v74
    v_and_b32 v11, 0xffff0000, v74
    v_pk_mul_f32 v[8:9], v[8:9], v[10:11]
    v_cvt_pk_bf16_f32 v12, v8, v9
    v_lshlrev_b32 v8, 16, v12
    v_and_b32 v9, 0xffff0000, v12
    v_pk_add_f32 v[6:7], v[6:7], v[8:9]
    v_lshlrev_b32 v8, 16, v35
    v_and_b32 v9, 0xffff0000, v35
    v_lshlrev_b32 v10, 16, v75
    v_and_b32 v11, 0xffff0000, v75
    v_pk_mul_f32 v[8:9], v[8:9], v[10:11]
    v_cvt_pk_bf16_f32 v12, v8, v9
    v_lshlrev_b32 v8, 16, v12
    v_and_b32 v9, 0xffff0000, v12
    v_pk_add_f32 v[6:7], v[6:7], v[8:9]
    s_waitcnt vmcnt(8)
    v_lshlrev_b32 v8, 16, v36
    v_and_b32 v9, 0xffff0000, v36
    v_lshlrev_b32 v10, 16, v76
    v_and_b32 v11, 0xffff0000, v76
    v_pk_mul_f32 v[8:9], v[8:9], v[10:11]
    v_cvt_pk_bf16_f32 v12, v8, v9
    v_lshlrev_b32 v8, 16, v12
    v_and_b32 v9, 0xffff0000, v12
    v_pk_add_f32 v[6:7], v[6:7], v[8:9]
    v_lshlrev_b32 v8, 16, v37
    v_and_b32 v9, 0xffff0000, v37
    v_lshlrev_b32 v10, 16, v77
    v_and_b32 v11, 0xffff0000, v77
    v_pk_mul_f32 v[8:9], v[8:9], v[10:11]
    v_cvt_pk_bf16_f32 v12, v8, v9
    v_lshlrev_b32 v8, 16, v12
    v_and_b32 v9, 0xffff0000, v12
    v_pk_add_f32 v[6:7], v[6:7], v[8:9]
    v_lshlrev_b32 v8, 16, v38
    v_and_b32 v9, 0xffff0000, v38
    v_lshlrev_b32 v10, 16, v78
    v_and_b32 v11, 0xffff0000, v78
    v_pk_mul_f32 v[8:9], v[8:9], v[10:11]
    v_cvt_pk_bf16_f32 v12, v8, v9
    v_lshlrev_b32 v8, 16, v12
    v_and_b32 v9, 0xffff0000, v12
    v_pk_add_f32 v[6:7], v[6:7], v[8:9]
    v_lshlrev_b32 v8, 16, v39
    v_and_b32 v9, 0xffff0000, v39
    v_lshlrev_b32 v10, 16, v79
    v_and_b32 v11, 0xffff0000, v79
    v_pk_mul_f32 v[8:9], v[8:9], v[10:11]
    v_cvt_pk_bf16_f32 v12, v8, v9
    v_lshlrev_b32 v8, 16, v12
    v_and_b32 v9, 0xffff0000, v12
    v_pk_add_f32 v[6:7], v[6:7], v[8:9]
    s_waitcnt vmcnt(6)
    v_lshlrev_b32 v8, 16, v40
    v_and_b32 v9, 0xffff0000, v40
    v_lshlrev_b32 v10, 16, v80
    v_and_b32 v11, 0xffff0000, v80
    v_pk_mul_f32 v[8:9], v[8:9], v[10:11]
    v_cvt_pk_bf16_f32 v12, v8, v9
    v_lshlrev_b32 v8, 16, v12
    v_and_b32 v9, 0xffff0000, v12
    v_pk_add_f32 v[6:7], v[6:7], v[8:9]
    v_lshlrev_b32 v8, 16, v41
    v_and_b32 v9, 0xffff0000, v41
    v_lshlrev_b32 v10, 16, v81
    v_and_b32 v11, 0xffff0000, v81
    v_pk_mul_f32 v[8:9], v[8:9], v[10:11]
    v_cvt_pk_bf16_f32 v12, v8, v9
    v_lshlrev_b32 v8, 16, v12
    v_and_b32 v9, 0xffff0000, v12
    v_pk_add_f32 v[6:7], v[6:7], v[8:9]
    v_lshlrev_b32 v8, 16, v42
    v_and_b32 v9, 0xffff0000, v42
    v_lshlrev_b32 v10, 16, v82
    v_and_b32 v11, 0xffff0000, v82
    v_pk_mul_f32 v[8:9], v[8:9], v[10:11]
    v_cvt_pk_bf16_f32 v12, v8, v9
    v_lshlrev_b32 v8, 16, v12
    v_and_b32 v9, 0xffff0000, v12
    v_pk_add_f32 v[6:7], v[6:7], v[8:9]
    v_lshlrev_b32 v8, 16, v43
    v_and_b32 v9, 0xffff0000, v43
    v_lshlrev_b32 v10, 16, v83
    v_and_b32 v11, 0xffff0000, v83
    v_pk_mul_f32 v[8:9], v[8:9], v[10:11]
    v_cvt_pk_bf16_f32 v12, v8, v9
    v_lshlrev_b32 v8, 16, v12
    v_and_b32 v9, 0xffff0000, v12
    v_pk_add_f32 v[6:7], v[6:7], v[8:9]
    s_waitcnt vmcnt(4)
    v_lshlrev_b32 v8, 16, v44
    v_and_b32 v9, 0xffff0000, v44
    v_lshlrev_b32 v10, 16, v84
    v_and_b32 v11, 0xffff0000, v84
    v_pk_mul_f32 v[8:9], v[8:9], v[10:11]
    v_cvt_pk_bf16_f32 v12, v8, v9
    v_lshlrev_b32 v8, 16, v12
    v_and_b32 v9, 0xffff0000, v12
    v_pk_add_f32 v[6:7], v[6:7], v[8:9]
    v_lshlrev_b32 v8, 16, v45
    v_and_b32 v9, 0xffff0000, v45
    v_lshlrev_b32 v10, 16, v85
    v_and_b32 v11, 0xffff0000, v85
    v_pk_mul_f32 v[8:9], v[8:9], v[10:11]
    v_cvt_pk_bf16_f32 v12, v8, v9
    v_lshlrev_b32 v8, 16, v12
    v_and_b32 v9, 0xffff0000, v12
    v_pk_add_f32 v[6:7], v[6:7], v[8:9]
    v_lshlrev_b32 v8, 16, v46
    v_and_b32 v9, 0xffff0000, v46
    v_lshlrev_b32 v10, 16, v86
    v_and_b32 v11, 0xffff0000, v86
    v_pk_mul_f32 v[8:9], v[8:9], v[10:11]
    v_cvt_pk_bf16_f32 v12, v8, v9
    v_lshlrev_b32 v8, 16, v12
    v_and_b32 v9, 0xffff0000, v12
    v_pk_add_f32 v[6:7], v[6:7], v[8:9]
    v_lshlrev_b32 v8, 16, v47
    v_and_b32 v9, 0xffff0000, v47
    v_lshlrev_b32 v10, 16, v87
    v_and_b32 v11, 0xffff0000, v87
    v_pk_mul_f32 v[8:9], v[8:9], v[10:11]
    v_cvt_pk_bf16_f32 v12, v8, v9
    v_lshlrev_b32 v8, 16, v12
    v_and_b32 v9, 0xffff0000, v12
    v_pk_add_f32 v[6:7], v[6:7], v[8:9]
    s_waitcnt vmcnt(2)
    v_lshlrev_b32 v8, 16, v48
    v_and_b32 v9, 0xffff0000, v48
    v_lshlrev_b32 v10, 16, v88
    v_and_b32 v11, 0xffff0000, v88
    v_pk_mul_f32 v[8:9], v[8:9], v[10:11]
    v_cvt_pk_bf16_f32 v12, v8, v9
    v_lshlrev_b32 v8, 16, v12
    v_and_b32 v9, 0xffff0000, v12
    v_pk_add_f32 v[6:7], v[6:7], v[8:9]
    v_lshlrev_b32 v8, 16, v49
    v_and_b32 v9, 0xffff0000, v49
    v_lshlrev_b32 v10, 16, v89
    v_and_b32 v11, 0xffff0000, v89
    v_pk_mul_f32 v[8:9], v[8:9], v[10:11]
    v_cvt_pk_bf16_f32 v12, v8, v9
    v_lshlrev_b32 v8, 16, v12
    v_and_b32 v9, 0xffff0000, v12
    v_pk_add_f32 v[6:7], v[6:7], v[8:9]
    v_lshlrev_b32 v8, 16, v50
    v_and_b32 v9, 0xffff0000, v50
    v_lshlrev_b32 v10, 16, v90
    v_and_b32 v11, 0xffff0000, v90
    v_pk_mul_f32 v[8:9], v[8:9], v[10:11]
    v_cvt_pk_bf16_f32 v12, v8, v9
    v_lshlrev_b32 v8, 16, v12
    v_and_b32 v9, 0xffff0000, v12
    v_pk_add_f32 v[6:7], v[6:7], v[8:9]
    v_lshlrev_b32 v8, 16, v51
    v_and_b32 v9, 0xffff0000, v51
    v_lshlrev_b32 v10, 16, v91
    v_and_b32 v11, 0xffff0000, v91
    v_pk_mul_f32 v[8:9], v[8:9], v[10:11]
    v_cvt_pk_bf16_f32 v12, v8, v9
    v_lshlrev_b32 v8, 16, v12
    v_and_b32 v9, 0xffff0000, v12
    v_pk_add_f32 v[6:7], v[6:7], v[8:9]
    s_waitcnt vmcnt(0)
    v_lshlrev_b32 v8, 16, v52
    v_and_b32 v9, 0xffff0000, v52
    v_lshlrev_b32 v10, 16, v92
    v_and_b32 v11, 0xffff0000, v92
    v_pk_mul_f32 v[8:9], v[8:9], v[10:11]
    v_cvt_pk_bf16_f32 v12, v8, v9
    v_lshlrev_b32 v8, 16, v12
    v_and_b32 v9, 0xffff0000, v12
    v_pk_add_f32 v[6:7], v[6:7], v[8:9]
    v_lshlrev_b32 v8, 16, v53
    v_and_b32 v9, 0xffff0000, v53
    v_lshlrev_b32 v10, 16, v93
    v_and_b32 v11, 0xffff0000, v93
    v_pk_mul_f32 v[8:9], v[8:9], v[10:11]
    v_cvt_pk_bf16_f32 v12, v8, v9
    v_lshlrev_b32 v8, 16, v12
    v_and_b32 v9, 0xffff0000, v12
    v_pk_add_f32 v[6:7], v[6:7], v[8:9]
    v_lshlrev_b32 v8, 16, v54
    v_and_b32 v9, 0xffff0000, v54
    v_lshlrev_b32 v10, 16, v94
    v_and_b32 v11, 0xffff0000, v94
    v_pk_mul_f32 v[8:9], v[8:9], v[10:11]
    v_cvt_pk_bf16_f32 v12, v8, v9
    v_lshlrev_b32 v8, 16, v12
    v_and_b32 v9, 0xffff0000, v12
    v_pk_add_f32 v[6:7], v[6:7], v[8:9]
    v_lshlrev_b32 v8, 16, v55
    v_and_b32 v9, 0xffff0000, v55
    v_lshlrev_b32 v10, 16, v95
    v_and_b32 v11, 0xffff0000, v95
    v_pk_mul_f32 v[8:9], v[8:9], v[10:11]
    v_cvt_pk_bf16_f32 v12, v8, v9
    v_lshlrev_b32 v8, 16, v12
    v_and_b32 v9, 0xffff0000, v12
    v_pk_add_f32 v[6:7], v[6:7], v[8:9]
    v_add_f32 v6, v6, v7
    s_nop 1
    v_add_f32_dpp v6, v6, v6 quad_perm:[1,0,3,2] row_mask:0xf bank_mask:0xf
    s_nop 1
    v_add_f32_dpp v6, v6, v6 quad_perm:[2,3,0,1] row_mask:0xf bank_mask:0xf
    s_nop 1
    v_add_f32_dpp v6, v6, v6 row_half_mirror row_mask:0xf bank_mask:0xf
    v_cvt_pk_bf16_f32 v6, v6, v6
    v_lshlrev_b32 v6, 16, v6
    v_mul_f32 v6, 0xbfb8aa3b, v6
    v_exp_f32 v6, v6
    s_nop 0
    v_add_f32 v6, 1.0, v6
    v_rcp_f32 v6, v6
    s_nop 0
    v_cvt_pk_bf16_f32 v6, v6, v6
    v_lshlrev_b32 v8, 16, v6
    v_sub_f32 v9, 1.0, v8
    v_cvt_pk_bf16_f32 v9, v9, v9
    v_lshlrev_b32 v9, 16, v9
    s_lshl_b32 s86, s82, 6
    s_add_u32 s86, s86, 32768
    v_lshlrev_b32 v10, 3, v2
    v_cmp_eq_u32 vcc, 0, v3
    s_nop 3
    s_and_saveexec_b64 s[84:85], vcc
    buffer_store_dwordx2 v[8:9], v10, s[68:71], s86 offen sc1
    s_waitcnt vmcnt(0)
    s_lshl_b32 s86, s82, 2
    s_add_u32 s86, s86, 20480
    v_mov_b32 v8, s80
    s_mov_b64 exec, 1
    buffer_store_dword v8, off, s[68:71], s86 sc1
    s_endpgm
L_retile:
    s_mov_b32 s64, s42
    s_and_b32 s65, s43, 0xffff
    s_mov_b32 s66, 983040
    s_mov_b32 s67, 0x00020000
    s_sub_u32 s82, s2, 384
    s_lshl_b32 s82, s82, 1
    v_add_u32 v2, 0, v1
    v_mul_u32_u24 v3, 52429, v2
    v_lshrrev_b32 v3, 19, v3
    v_mul_u32_u24 v4, 10, v3
    v_sub_u32 v2, v2, v4
    v_mul_u32_u24 v3, 1280, v3
    v_lshl_add_u32 v10, v2, 4, v3
    v_add_u32 v2, 64, v1
    v_mul_u32_u24 v3, 52429, v2
    v_lshrrev_b32 v3, 19, v3
    v_mul_u32_u24 v4, 10, v3
    v_sub_u32 v2, v2, v4
    v_mul_u32_u24 v3, 1280, v3
    v_lshl_add_u32 v11, v2, 4, v3
    v_add_u32 v2, 128, v1
    v_mul_u32_u24 v3, 52429, v2
    v_lshrrev_b32 v3, 19, v3
    v_mul_u32_u24 v4, 10, v3
    v_sub_u32 v2, v2, v4
    v_mul_u32_u24 v3, 1280, v3
    v_lshl_add_u32 v12, v2, 4, v3
    v_add_u32 v2, 192, v1
    v_mul_u32_u24 v3, 52429, v2
    v_lshrrev_b32 v3, 19, v3
    v_mul_u32_u24 v4, 10, v3
    v_sub_u32 v2, v2, v4
    v_mul_u32_u24 v3, 1280, v3
    v_lshl_add_u32 v13, v2, 4, v3
    v_add_u32 v2, 256, v1
    v_mul_u32_u24 v3, 52429, v2
    v_lshrrev_b32 v3, 19, v3
    v_mul_u32_u24 v4, 10, v3
    v_sub_u32 v2, v2, v4
    v_mul_u32_u24 v3, 1280, v3
    v_lshl_add_u32 v14, v2, 4, v3
    s_add_u32 s83, s82, 0
    s_mul_i32 s86, s83, 43691
    s_lshr_b32 s86, s86, 20
    s_mul_i32 s87, s86, 24
    s_sub_u32 s87, s83, s87
    s_mul_i32 s87, s87, 40960
    s_mul_i32 s86, s86, 160
    s_add_u32 s88, s86, s87
    s_mov_b32 m0, 53248
    s_nop 0
    buffer_load_dwordx4 v10, s[64:67], s88 offen lds
    s_mov_b32 m0, 54272
    s_nop 0
    buffer_load_dwordx4 v11, s[64:67], s88 offen lds
    s_mov_b32 m0, 55296
    s_nop 0
    buffer_load_dwordx4 v12, s[64:67], s88 offen lds
    s_mov_b32 m0, 56320
    s_nop 0
    buffer_load_dwordx4 v13, s[64:67], s88 offen lds
    s_mov_b32 m0, 57344
    s_nop 0
    buffer_load_dwordx4 v14, s[64:67], s88 offen lds
    s_add_u32 s83, s82, 1
    s_mul_i32 s86, s83, 43691
    s_lshr_b32 s86, s86, 20
    s_mul_i32 s87, s86, 24
    s_sub_u32 s87, s83, s87
    s_mul_i32 s87, s87, 40960
    s_mul_i32 s86, s86, 160
    s_add_u32 s88, s86, s87
    s_mov_b32 m0, 58368
    s_nop 0
    buffer_load_dwordx4 v10, s[64:67], s88 offen lds
    s_mov_b32 m0, 59392
    s_nop 0
    buffer_load_dwordx4 v11, s[64:67], s88 offen lds
    s_mov_b32 m0, 60416
    s_nop 0
    buffer_load_dwordx4 v12, s[64:67], s88 offen lds
    s_mov_b32 m0, 61440
    s_nop 0
    buffer_load_dwordx4 v13, s[64:67], s88 offen lds
    s_mov_b32 m0, 62464
    s_nop 0
    buffer_load_dwordx4 v14, s[64:67], s88 offen lds
    v_lshrrev_b32 v2, 4, v1
    v_bfe_u32 v3, v1, 2, 2
    v_lshl_add_u32 v2, v2, 3, v3
    v_mul_u32_u24 v2, 160, v2
    v_and_b32 v3, 3, v1
    v_lshl_add_u32 v2, v3, 3, v2
    v_add_u32 v2, 53248, v2
    v_lshlrev_b32 v5, 4, v1
    s_mul_i32 s86, s82, 5120
    s_add_u32 s86, s86, 13631488
    s_waitcnt vmcnt(0)
    v_readfirstlane_b32 s80, v127
    s_nop 3
    s_add_u32 s80, s80, 1
    ds_read_b64_tr_b16 v[16:17], v2 offset:0
    ds_read_b64_tr_b16 v[18:19], v2 offset:640
    ds_read_b64_tr_b16 v[20:21], v2 offset:32
    ds_read_b64_tr_b16 v[22:23], v2 offset:672
    ds_read_b64_tr_b16 v[24:25], v2 offset:64
    ds_read_b64_tr_b16 v[26:27], v2 offset:704
    ds_read_b64_tr_b16 v[28:29], v2 offset:96
    ds_read_b64_tr_b16 v[30:31], v2 offset:736
    ds_read_b64_tr_b16 v[32:33], v2 offset:128
    ds_read_b64_tr_b16 v[34:35], v2 offset:768
    ds_read_b64_tr_b16 v[36:37], v2 offset:5120
    ds_read_b64_tr_b16 v[38:39], v2 offset:5760
    ds_read_b64_tr_b16 v[40:41], v2 offset:5152
    ds_read_b64_tr_b16 v[42:43], v2 offset:5792
    ds_read_b64_tr_b16 v[44:45], v2 offset:5184
    ds_read_b64_tr_b16 v[46:47], v2 offset:5824
    ds_read_b64_tr_b16 v[48:49], v2 offset:5216
    ds_read_b64_tr_b16 v[50:51], v2 offset:5856
    ds_read_b64_tr_b16 v[52:53], v2 offset:5248
    ds_read_b64_tr_b16 v[54:55], v2 offset:5888
    s_waitcnt lgkmcnt(0)
    buffer_store_dwordx4 v[16:19], v5, s[68:71], s86 offen offset:0 sc1
    buffer_store_dwordx4 v[20:23], v5, s[68:71], s86 offen offset:1024 sc1
    buffer_store_dwordx4 v[24:27], v5, s[68:71], s86 offen offset:2048 sc1
    buffer_store_dwordx4 v[28:31], v5, s[68:71], s86 offen offset:3072 sc1
    s_add_u32 s86, s86, 4096
    buffer_store_dwordx4 v[32:35], v5, s[68:71], s86 offen offset:0 sc1
    s_add_u32 s86, s86, 1024
    buffer_store_dwordx4 v[36:39], v5, s[68:71], s86 offen offset:0 sc1
    buffer_store_dwordx4 v[40:43], v5, s[68:71], s86 offen offset:1024 sc1
    buffer_store_dwordx4 v[44:47], v5, s[68:71], s86 offen offset:2048 sc1
    buffer_store_dwordx4 v[48:51], v5, s[68:71], s86 offen offset:3072 sc1
    s_add_u32 s86, s86, 4096
    buffer_store_dwordx4 v[52:55], v5, s[68:71], s86 offen offset:0 sc1
    s_add_u32 s86, s86, 1024
    s_waitcnt vmcnt(0)
    s_lshl_b32 s86, s82, 2
    s_add_u32 s86, s86, 24576
    v_mov_b32 v8, s80
    v_mov_b32 v9, s80
    s_mov_b64 exec, 1
    buffer_store_dwordx2 v[8:9], off, s[68:71], s86 sc1
    s_endpgm
L_keep:
    s_waitcnt vmcnt(0)
    v_readfirstlane_b32 s80, v127
    s_nop 3
    s_add_u32 s80, s80, 1
    v_lshlrev_b32 v2, 2, v1
    s_mov_b32 s86, 4096
    s_mov_b32 s87, 16384
    s_mov_b32 s88, 20480
    s_mov_b32 s90, 24576
    s_mov_b32 s89, 100000
L_keep_spin:
    buffer_load_dword v8, v2, s[68:71], s86 offen offset:0 sc1
    buffer_load_dword v9, v2, s[68:71], s86 offen offset:256 sc1
    buffer_load_dword v10, v2, s[68:71], s86 offen offset:512 sc1
    buffer_load_dword v11, v2, s[68:71], s86 offen offset:768 sc1
    buffer_load_dword v12, v2, s[68:71], s87 offen offset:0 sc1
    buffer_load_dword v13, v2, s[68:71], s87 offen offset:256 sc1
    buffer_load_dword v14, v2, s[68:71], s87 offen offset:512 sc1
    buffer_load_dword v15, v2, s[68:71], s87 offen offset:768 sc1
    buffer_load_dword v16, v2, s[68:71], s87 offen offset:1024 sc1
    buffer_load_dword v17, v2, s[68:71], s87 offen offset:1280 sc1
    buffer_load_dword v18, v2, s[68:71], s87 offen offset:1536 sc1
    buffer_load_dword v19, v2, s[68:71], s87 offen offset:1792 sc1
    buffer_load_dword v20, v2, s[68:71], s87 offen offset:2048 sc1
    buffer_load_dword v21, v2, s[68:71], s87 offen offset:2304 sc1
    buffer_load_dword v22, v2, s[68:71], s88 offen offset:0 sc1
    buffer_load_dword v23, v2, s[68:71], s88 offen offset:256 sc1
    buffer_load_dword v24, v2, s[68:71], s88 offen offset:512 sc1
    buffer_load_dword v25, v2, s[68:71], s88 offen offset:768 sc1
    buffer_load_dword v26, v2, s[68:71], s90 offen offset:0 sc1
    buffer_load_dword v27, v2, s[68:71], s90 offen offset:256 sc1
    buffer_load_dword v28, v2, s[68:71], s90 offen offset:512 sc1
    s_waitcnt vmcnt(0)
    v_cmp_ne_u32 vcc, s80, v8
    v_cmp_ne_u32 s[84:85], s80, v9
    s_nop 3
    s_or_b64 vcc, vcc, s[84:85]
    v_cmp_ne_u32 s[84:85], s80, v10
    s_nop 3
    s_or_b64 vcc, vcc, s[84:85]
    v_cmp_ne_u32 s[84:85], s80, v11
    s_nop 3
    s_or_b64 vcc, vcc, s[84:85]
    v_cmp_ne_u32 s[84:85], s80, v12
    s_nop 3
    s_or_b64 vcc, vcc, s[84:85]
    v_cmp_ne_u32 s[84:85], s80, v13
    s_nop 3
    s_or_b64 vcc, vcc, s[84:85]
    v_cmp_ne_u32 s[84:85], s80, v14
    s_nop 3
    s_or_b64 vcc, vcc, s[84:85]
    v_cmp_ne_u32 s[84:85], s80, v15
    s_nop 3
    s_or_b64 vcc, vcc, s[84:85]
    v_cmp_ne_u32 s[84:85], s80, v16
    s_nop 3
    s_or_b64 vcc, vcc, s[84:85]
    v_cmp_ne_u32 s[84:85], s80, v17
    s_nop 3
    s_or_b64 vcc, vcc, s[84:85]
    v_cmp_ne_u32 s[84:85], s80, v18
    s_nop 3
    s_or_b64 vcc, vcc, s[84:85]
    v_cmp_ne_u32 s[84:85], s80, v19
    s_nop 3
    s_or_b64 vcc, vcc, s[84:85]
    v_cmp_ne_u32 s[84:85], s80, v20
    s_nop 3
    s_or_b64 vcc, vcc, s[84:85]
    v_cmp_ne_u32 s[84:85], s80, v21
    s_nop 3
    s_or_b64 vcc, vcc, s[84:85]
    v_cmp_ne_u32 s[84:85], s80, v22
    s_nop 3
    s_or_b64 vcc, vcc, s[84:85]
    v_cmp_ne_u32 s[84:85], s80, v23
    s_nop 3
    s_or_b64 vcc, vcc, s[84:85]
    v_cmp_ne_u32 s[84:85], s80, v24
    s_nop 3
    s_or_b64 vcc, vcc, s[84:85]
    v_cmp_ne_u32 s[84:85], s80, v25
    s_nop 3
    s_or_b64 vcc, vcc, s[84:85]
    v_cmp_ne_u32 s[84:85], s80, v26
    s_nop 3
    s_or_b64 vcc, vcc, s[84:85]
    v_cmp_ne_u32 s[84:85], s80, v27
    s_nop 3
    s_or_b64 vcc, vcc, s[84:85]
    v_cmp_ne_u32 s[84:85], s80, v28
    s_nop 3
    s_or_b64 vcc, vcc, s[84:85]
    s_cbranch_vccz L_keep_done
    s_sleep 64
    s_sub_u32 s89, s89, 1
    s_cmp_lg_u32 s89, 0
    s_cbranch_scc1 L_keep_spin
L_keep_done:
    v_mov_b32 v8, s80
    s_mov_b64 exec, 1
    buffer_store_dword v8, off, s[68:71], 0 sc1
    s_endpgm
.section .rodata,"a"
.p2align 6
.amdhsa_kernel gated_mix__ssm_conv_s4__mixer_gmlp__prompt_kernel
  .amdhsa_next_free_vgpr 256
  .amdhsa_next_free_sgpr 96
  .amdhsa_accum_offset 256
  .amdhsa_group_segment_fixed_size 0
  .amdhsa_kernarg_size 144
  .amdhsa_user_sgpr_count 2
  .amdhsa_user_sgpr_kernarg_segment_ptr 1
  .amdhsa_system_sgpr_workgroup_id_x 1
.end_amdhsa_kernel
```
